```python
import torch

def _softmax(x, axis=-1):
    return torch.softmax(x, dim=axis)
def _gelu(x):
    return torch.nn.functional.gelu(x, approximate="tanh")
def _silu(x):
    return torch.nn.functional.silu(x)
def _sigmoid(x):
    return torch.sigmoid(x)
def _layernorm(x, axis=-1, eps=1e-5):
    m = x.mean(dim=axis, keepdim=True)
    v = x.var(dim=axis, keepdim=True, unbiased=False)
    return (x - m) / torch.sqrt(v + eps)
def _scatter_add(tgt, idx, src, axis=0):
    return tgt.clone().index_add_(axis, idx, src)
def _segment_sum(src, seg, n):
    out = torch.zeros((n,) + src.shape[1:], dtype=src.dtype)
    return out.index_add_(0, seg, src)
def _pad(x, pw):
    flat = tuple(v for pair in reversed(pw) for v in pair)
    return torch.nn.functional.pad(x, flat)

kernel_name = 'standalone__paged_block_table_kv_pagedattention__sampling'

def setup_inputs():

    _w = (lambda a: (lambda t: t.to(torch.bfloat16) if t.is_floating_point() else t)(torch.as_tensor(a)))
    B, Hq, Hkv, Sq, Skv, D = 8, 32, 32, 16, 2048, 128
    bs = 16
    nbps = max(1, Skv // bs)
    num_phys = B * nbps + 4
    bt = torch.randperm(num_phys)[: B * nbps].reshape(B, nbps).to(torch.int64)
    cl = (nbps * bs - (torch.arange(1, B + 1, dtype=torch.int64) * 2654435761) % max(1, nbps * bs // 2)).to(torch.int64)
    return {
        "q": _w((lambda *s: torch.randn(*s, dtype=torch.bfloat16) * 0.8)(B, Hq, Sq, D)),
        "k_cache": _w((lambda *s: torch.randn(*s, dtype=torch.bfloat16) * 0.8)(num_phys, bs, Hkv, D)),
        "v_cache": _w((lambda *s: torch.randn(*s, dtype=torch.bfloat16) * 0.05)(num_phys, bs, Hkv, D)),
        "block_table": _w(bt),
        "context_lens": _w(cl),
    }

def reference(q, k_cache, v_cache, block_table, context_lens):
    B, Hq, Sq, D = q.shape
    bs = k_cache.shape[1]
    Hkv = k_cache.shape[2]
    nbps = block_table.shape[1]
    Skv = nbps * bs
    bt = block_table.reshape(-1)
    k = (lambda x, *d: x.permute(*d))(k_cache[bt].reshape(B, Skv, Hkv, D), 0, 2, 1, 3)
    v = (lambda x, *d: x.permute(*d))(v_cache[bt].reshape(B, Skv, Hkv, D), 0, 2, 1, 3)
    g = Hq // Hkv
    qg = q.reshape(B, Hkv, g, Sq, D)
    scores = torch.einsum("bhgqd,bhkd->bhgqk", qg, k) * (D ** -0.5)
    pos = torch.arange(Skv)
    msk = pos[None, :] < context_lens[:, None]
    scores = torch.where(msk[:, None, None, None, :], scores, -1e9)
    p = _softmax(scores, axis=-1)
    out = torch.einsum("bhgqk,bhkd->bhgqd", p, v)
    return out.reshape(B, Hq, Sq, D)
```

```asm
; @launch grid=(256,1,1) block=(192,1,1) lds=155136
.amdgcn_target "amdgcn-amd-amdhsa--gfx950"
.text
.globl standalone__paged_block_table_kv_pagedattention__sampling_kernel
.p2align 8
.type standalone__paged_block_table_kv_pagedattention__sampling_kernel,@function
standalone__paged_block_table_kv_pagedattention__sampling_kernel:
s_load_dwordx8 s[4:11], s[0:1], 0
s_load_dwordx8 s[12:19], s[0:1], 32
v_readfirstlane_b32 s3, v0
s_lshr_b32 s36, s2, 5
s_cmp_ge_u32 s2, 256
s_cbranch_scc1 L_end
s_cmp_eq_u32 s3, 0
s_cbranch_scc1 L_load
s_getpc_b64 s[72:73]
L_pc:
v_lshlrev_b32 v4, 6, v0
v_add_u32 v5, -4096, v4
v_min_u32 v5, L_end-L_pc, v5
global_load_dword v150, v5, s[72:73]
v_add_u32 v5, 4096, v4
v_min_u32 v5, L_end-L_pc, v5
global_load_dword v151, v5, s[72:73]
v_add_u32 v5, 12288, v4
v_min_u32 v5, L_end-L_pc, v5
global_load_dword v152, v5, s[72:73]
s_branch L_cons
L_load:
s_lshl_b32 s43, s36, 2
s_lshl_b32 s44, s36, 9
s_waitcnt lgkmcnt(0)
s_load_dwordx2 s[40:41], s[10:11], s44
s_load_dword s39, s[12:13], s43
s_add_u32 s44, s44, 8
s_load_dwordx4 s[24:27], s[10:11], s44
s_and_b32 s100, s2, 5
s_cmp_eq_u32 s100, 5
s_cselect_b32 s100, 2, 0
s_xor_b32 s38, s100, s2
s_and_b32 s37, s38, 31
v_and_b32 v1, 15, v0
v_bfe_u32 v2, v0, 4, 2
v_and_b32 v3, 63, v0
s_mov_b32 s34, 32
s_mov_b32 s35, 0x20000
v_lshlrev_b32 v28, 4, v3
v_and_b32 v35, 7, v3
v_lshlrev_b32 v35, 2, v35
v_lshrrev_b32 v36, 3, v3
v_lshlrev_b32 v36, 2, v36
s_mov_b32 s32, s12
s_mov_b32 s33, s13
s_mov_b32 s28, s10
s_mov_b32 s29, s11
s_mov_b32 s30, 4096
s_mov_b32 s31, 0x20000
s_mov_b32 m0, 143360
buffer_load_dword v35, v35, s[32:35], 0 offen
buffer_load_dword v36, v36, s[32:35], 0 offen
buffer_load_dwordx4 v28, s[28:31], 0 offen offset:0 lds
buffer_load_dwordx4 v28, s[28:31], 0 offen offset:1024 lds
buffer_load_dwordx4 v28, s[28:31], 0 offen offset:2048 lds
buffer_load_dwordx4 v28, s[28:31], 0 offen offset:3072 lds
v_xor_b32 v26, v1, v2
v_lshlrev_b32 v26, 4, v26
v_lshl_add_u32 v4, v2, 13, v26
v_xor_b32 v5, 64, v4
v_add_u32 v5, 31744, v5
v_xor_b32 v6, 128, v4
v_add_u32 v6, 63488, v6
v_xor_b32 v7, 192, v4
v_add_u32 v7, 95232, v7
v_mov_b32 v16, v4
v_mov_b32 v20, v4
v_mov_b32 v17, v5
v_mov_b32 v21, v5
v_mov_b32 v18, v6
v_mov_b32 v22, v6
v_mov_b32 v19, v7
v_mov_b32 v23, v7
s_lshl_b32 s37, s37, 8
s_mov_b32 s20, s6
s_mov_b32 s21, s7
s_mov_b32 s22, 0x8080000
s_mov_b32 s23, 0x20000
v_lshlrev_b32 v31, 2, v3
v_add_u32 v31, 151552, v31
s_mov_b32 m0, 0
s_waitcnt lgkmcnt(0)
s_sub_u32 s39, s39, 1
s_min_u32 s39, s39, 2047
s_lshl_b32 s40, s40, 17
s_lshl_b32 s41, s41, 17
s_or_b32 s40, s40, s37
s_or_b32 s41, s41, s37
s_and_b32 s59, s39, 31
s_add_u32 s59, s59, 1
s_lshr_b32 s49, s39, 5
s_cbranch_scc0 L_one
L_U0:
buffer_load_dwordx4 v16, s[20:23], s40 offen offset:0 nt lds
buffer_load_dwordx4 v17, s[20:23], s40 offen offset:1024 nt lds
buffer_load_dwordx4 v18, s[20:23], s40 offen offset:2048 nt lds
buffer_load_dwordx4 v19, s[20:23], s40 offen offset:3072 nt lds
s_add_u32 m0, m0, 4096
s_nop 0
buffer_load_dwordx4 v20, s[20:23], s41 offen offset:0 nt lds
buffer_load_dwordx4 v21, s[20:23], s41 offen offset:1024 nt lds
buffer_load_dwordx4 v22, s[20:23], s41 offen offset:2048 nt lds
buffer_load_dwordx4 v23, s[20:23], s41 offen offset:3072 nt lds
s_cmp_lt_u32 s49, 11
s_cselect_b32 s52, 1, 3
s_cbranch_scc1 L_noearly
s_lshl_b32 s24, s24, 17
s_movk_i32 m0, 0x4000
s_or_b32 s24, s24, s37
buffer_load_dwordx4 v4, s[20:23], s24 offen offset:0 nt lds
buffer_load_dwordx4 v5, s[20:23], s24 offen offset:1024 nt lds
buffer_load_dwordx4 v6, s[20:23], s24 offen offset:2048 nt lds
buffer_load_dwordx4 v7, s[20:23], s24 offen offset:3072 nt lds
s_lshl_b32 s25, s25, 17
s_movk_i32 m0, 0x5000
s_or_b32 s25, s25, s37
buffer_load_dwordx4 v4, s[20:23], s25 offen offset:0 nt lds
buffer_load_dwordx4 v5, s[20:23], s25 offen offset:1024 nt lds
buffer_load_dwordx4 v6, s[20:23], s25 offen offset:2048 nt lds
buffer_load_dwordx4 v7, s[20:23], s25 offen offset:3072 nt lds
s_lshl_b32 s26, s26, 17
s_mov_b32 m0, 0x8000
s_or_b32 s26, s26, s37
buffer_load_dwordx4 v4, s[20:23], s26 offen offset:0 nt lds
buffer_load_dwordx4 v5, s[20:23], s26 offen offset:1024 nt lds
buffer_load_dwordx4 v6, s[20:23], s26 offen offset:2048 nt lds
buffer_load_dwordx4 v7, s[20:23], s26 offen offset:3072 nt lds
s_lshl_b32 s27, s27, 17
s_mov_b32 m0, 0x9000
s_or_b32 s27, s27, s37
buffer_load_dwordx4 v4, s[20:23], s27 offen offset:0 nt lds
buffer_load_dwordx4 v5, s[20:23], s27 offen offset:1024 nt lds
buffer_load_dwordx4 v6, s[20:23], s27 offen offset:2048 nt lds
buffer_load_dwordx4 v7, s[20:23], s27 offen offset:3072 nt lds
s_waitcnt vmcnt(24)
s_branch L_early1
L_noearly:
s_waitcnt vmcnt(8)
L_early1:
v_add_u32 v29, -1, v35
v_min_u32 v29, 0x7ff, v29
v_lshrrev_b32 v29, 5, v29
v_add_u32 v28, -1, v36
v_min_u32 v28, 0x7ff, v28
v_lshrrev_b32 v28, 5, v28
v_add_u32_dpp v35, v29, v29 row_shr:1 row_mask:0xf bank_mask:0xf bound_ctrl:0
v_and_b32 v26, 7, v3
v_lshl_add_u32 v29, v29, 3, v26
v_add_u32_dpp v35, v35, v35 row_shr:2 row_mask:0xf bank_mask:0xf bound_ctrl:0
v_lshrrev_b32 v26, 3, v3
v_lshl_add_u32 v27, v28, 3, v26
v_add_u32_dpp v35, v35, v35 row_shr:4 row_mask:0xf bank_mask:0xf bound_ctrl:0
v_cmp_gt_u32 s[72:73], v29, v27
v_readlane_b32 s45, v35, 7
v_and_b32 v29, 56, v3
s_lshl_b32 s43, s36, 3
v_lshrrev_b64 v[26:27], v29, s[72:73]
v_and_b32 v26, 0xff, v26
v_bcnt_u32_b32 v26, v26, 0
v_readlane_b32 s49, v28, s43
v_readlane_b32 s56, v26, s43
s_nop 1
s_sub_u32 s57, 7, s56
v_cmp_eq_u32 s[74:75], s57, v26
s_nop 1
s_ff1_i32_b64 s44, s[74:75]
s_lshr_b32 s58, s44, 3
v_readlane_b32 s43, v28, s44
s_nop 1
s_max_u32 s57, s43, s49
s_min_u32 s43, s43, s49
s_sub_u32 s57, s57, s43
s_lshr_b32 s57, s57, 1
s_min_u32 s43, s57, s43
s_cmp_lt_u32 s56, 4
s_cselect_b32 s56, s43, 0
s_cselect_b32 s57, 0, s43
s_sub_u32 s49, s49, s56
s_add_u32 s49, s49, s57
v_readlane_b32 s48, v28, s44
v_lshrrev_b32 v26, 1, v3
v_min_u32 v27, s57, v26
v_sub_u32 v27, v3, v27
v_add_u32 v28, 1, v3
v_lshrrev_b32 v28, 1, v28
v_min_u32 v28, s52, v28
v_sub_u32 v27, v27, v28
s_add_u32 s43, s52, s56
v_add_u32 v27, s43, v27
v_and_b32 v28, 1, v3
v_cmp_eq_u32 s[72:73], 0, v28
v_cmp_gt_u32 vcc, s52, v26
s_cmp_lt_u32 s48, 11
s_cselect_b32 s48, 1, 3
s_and_b64 vcc, vcc, s[72:73]
v_cndmask_b32 v27, v27, v26, vcc
v_cmp_gt_u32 vcc, s57, v26
v_add_u32 v26, s48, v26
v_mov_b32 v29, s36
v_mov_b32 v28, s58
s_andn2_b64 vcc, vcc, s[72:73]
v_cndmask_b32 v27, v27, v26, vcc
v_cndmask_b32 v29, v29, v28, vcc
v_min_u32 v27, 63, v27
v_lshlrev_b32 v27, 3, v27
v_lshl_add_u32 v27, v29, 9, v27
v_add_u32 v27, 143360, v27
ds_read_b64 v[24:25], v27
v_and_b32 v35, 0x1f8, v27
v_add_u32 v35, 154624, v35
v_cndmask_b32 v35, v35, v27, vcc
v_mov_b32 v29, s37
s_add_u32 s50, s49, 1
s_lshl_b32 s61, s50, 1
s_sub_u32 s98, s61, 3
s_cmp_ge_u32 s50, 4
s_cselect_b32 s99, s98, -1
s_mov_b32 s42, 1
s_mov_b32 s53, 1
s_movk_i32 s54, 0x2000
s_add_u32 s45, s45, 8
s_mul_i32 s97, s50, 1904
s_getreg_b32 s47, hwreg(HW_REG_XCC_ID, 0, 3)
s_lshl_b32 s47, s47, 2
s_lshr_b32 s47, 0x23560513, s47
s_and_b32 s47, s47, 15
s_mul_i32 s47, s47, s45
s_add_u32 s97, s97, s47
s_waitcnt lgkmcnt(0)
v_lshl_add_u32 v24, v24, 17, v29
v_lshl_add_u32 v25, v25, 17, v29
s_barrier
s_cmp_eq_u32 s52, 1
s_cbranch_scc1 L_short
v_mov_b32 v27, 0x40000000
v_mov_b32 v30, 0
s_movk_i32 s44, 0x6531
L_pre:
s_and_b32 s43, s44, 15
v_readlane_b32 s40, v24, s43
v_readlane_b32 s41, v25, s43
s_lshl_b32 m0, s43, 13
s_nop 2
buffer_load_dwordx4 v16, s[20:23], s40 offen offset:0 nt lds
v_add_u32 v26, 0, v2
v_cmp_gt_u32 vcc, s59, v26
ds_read_b32 v28, v31 offset:768
s_nop 0
v_cndmask_b32 v8, v27, v4, vcc
s_waitcnt vmcnt(20)
buffer_load_dwordx4 v17, s[20:23], s40 offen offset:1024 nt lds
v_add_u32 v26, 4, v2
v_cmp_gt_u32 vcc, s59, v26
ds_read_b64 v[32:33], v35
s_nop 0
v_cndmask_b32 v9, v27, v5, vcc
s_waitcnt vmcnt(20)
buffer_load_dwordx4 v18, s[20:23], s40 offen offset:2048 nt lds
v_add_u32 v26, 8, v2
v_cmp_gt_u32 vcc, s59, v26
s_nop 0
s_nop 0
v_cndmask_b32 v10, v27, v6, vcc
s_waitcnt vmcnt(20)
buffer_load_dwordx4 v19, s[20:23], s40 offen offset:3072 nt lds
v_add_u32 v26, 12, v2
v_cmp_gt_u32 vcc, s59, v26
s_add_u32 m0, m0, 4096
s_nop 0
v_cndmask_b32 v11, v27, v7, vcc
s_waitcnt vmcnt(20)
v_add_u32 v30, 1, v30
ds_write_b32 v31, v30
buffer_load_dwordx4 v20, s[20:23], s41 offen offset:0 nt lds
v_add_u32 v26, 16, v2
v_cmp_gt_u32 vcc, s59, v26
s_nop 0
s_nop 0
v_cndmask_b32 v12, v27, v4, vcc
s_waitcnt vmcnt(20)
buffer_load_dwordx4 v21, s[20:23], s41 offen offset:1024 nt lds
v_add_u32 v26, 20, v2
v_cmp_gt_u32 vcc, s59, v26
s_nop 0
s_nop 0
v_cndmask_b32 v13, v27, v5, vcc
s_waitcnt vmcnt(20)
buffer_load_dwordx4 v22, s[20:23], s41 offen offset:2048 nt lds
v_add_u32 v26, 24, v2
v_cmp_gt_u32 vcc, s59, v26
s_nop 0
s_nop 0
v_cndmask_b32 v14, v27, v6, vcc
s_waitcnt vmcnt(20)
buffer_load_dwordx4 v23, s[20:23], s41 offen offset:3072 nt lds
v_add_u32 v26, 28, v2
v_cmp_gt_u32 vcc, s59, v26
s_nop 0
s_nop 0
v_cndmask_b32 v15, v27, v7, vcc
s_waitcnt vmcnt(20)
s_lshr_b32 s44, s44, 4
s_cbranch_scc1 L_pre
L_srt:
s_waitcnt lgkmcnt(0)
v_readfirstlane_b32 s43, v28
s_cmp_lg_u32 s43, 0
s_cbranch_scc1 L_srt2
ds_read_b32 v28, v31 offset:768
ds_read_b64 v[32:33], v35
s_branch L_srt
L_srt2:
v_lshl_add_u32 v24, v32, 17, v29
v_lshl_add_u32 v25, v33, 17, v29
s_mov_b32 s42, 7
s_mov_b32 s53, 7
s_mov_b32 s54, 0xe000
L_nopre:
s_cmp_lg_u32 s42, s50
s_cbranch_scc1 L_ev1
s_mov_b32 s20, s8
s_mov_b32 s21, s9
s_mov_b32 s53, 0
L_ev1:
v_readlane_b32 s40, v24, s53
v_readlane_b32 s41, v25, s53
s_cmp_eq_u32 s53, s49
s_cselect_b64 s[72:73], -1, 0
v_cndmask_b32 v16, v4, v8, s[72:73]
v_cndmask_b32 v17, v5, v9, s[72:73]
v_cndmask_b32 v18, v6, v10, s[72:73]
v_cndmask_b32 v19, v7, v11, s[72:73]
L_evt:
s_cmp_eq_u32 s42, s61
s_cbranch_scc1 L_drain
s_mov_b32 s62, s61
s_cmp_eq_u32 s42, s99
s_cbranch_scc1 L_tail
s_cmp_ge_i32 s42, s98
s_cbranch_scc1 L_N2104
s_mov_b32 s62, s98
L_resel:
s_mov_b32 s46, s97
s_mul_i32 s47, s45, 237
s_cmp_le_u32 s46, s47
s_cbranch_scc1 L_bs0_13
s_mul_i32 s47, s45, 251
s_cmp_le_u32 s46, s47
s_cbranch_scc1 L_bs14_20
s_mul_i32 s47, s45, 266
s_cmp_le_u32 s46, s47
s_cbranch_scc1 L_bs21_24
s_mul_i32 s47, s45, 306
s_cmp_le_u32 s46, s47
s_cbranch_scc1 L_bs25_26
s_branch L_N128
L_bs25_26:
s_mul_i32 s47, s45, 282
s_cmp_le_u32 s46, s47
s_cbranch_scc1 L_N104
s_branch L_N112
L_bs21_24:
s_mul_i32 s47, s45, 255
s_cmp_le_u32 s46, s47
s_cbranch_scc1 L_bs21_22
s_mul_i32 s47, s45, 257
s_cmp_le_u32 s46, s47
s_cbranch_scc1 L_N95
s_branch L_N96
L_bs21_22:
s_mul_i32 s47, s45, 253
s_cmp_le_u32 s46, s47
s_cbranch_scc1 L_N93
s_branch L_N94
L_bs14_20:
s_mul_i32 s47, s45, 245
s_cmp_le_u32 s46, s47
s_cbranch_scc1 L_bs14_17
s_mul_i32 s47, s45, 249
s_cmp_le_u32 s46, s47
s_cbranch_scc1 L_bs18_19
s_branch L_N92
L_bs18_19:
s_mul_i32 s47, s45, 247
s_cmp_le_u32 s46, s47
s_cbranch_scc1 L_N90
s_branch L_N91
L_bs14_17:
s_mul_i32 s47, s45, 241
s_cmp_le_u32 s46, s47
s_cbranch_scc1 L_bs14_15
s_mul_i32 s47, s45, 243
s_cmp_le_u32 s46, s47
s_cbranch_scc1 L_N88
s_branch L_N89
L_bs14_15:
s_mul_i32 s47, s45, 239
s_cmp_le_u32 s46, s47
s_cbranch_scc1 L_N86
s_branch L_N87
L_bs0_13:
s_mul_i32 s47, s45, 223
s_cmp_le_u32 s46, s47
s_cbranch_scc1 L_bs0_6
s_mul_i32 s47, s45, 231
s_cmp_le_u32 s46, s47
s_cbranch_scc1 L_bs7_10
s_mul_i32 s47, s45, 235
s_cmp_le_u32 s46, s47
s_cbranch_scc1 L_bs11_12
s_branch L_N85
L_bs11_12:
s_mul_i32 s47, s45, 233
s_cmp_le_u32 s46, s47
s_cbranch_scc1 L_N83
s_branch L_N84
L_bs7_10:
s_mul_i32 s47, s45, 227
s_cmp_le_u32 s46, s47
s_cbranch_scc1 L_bs7_8
s_mul_i32 s47, s45, 229
s_cmp_le_u32 s46, s47
s_cbranch_scc1 L_N81
s_branch L_N82
L_bs7_8:
s_mul_i32 s47, s45, 225
s_cmp_le_u32 s46, s47
s_cbranch_scc1 L_N79
s_branch L_N80
L_bs0_6:
s_mul_i32 s47, s45, 214
s_cmp_le_u32 s46, s47
s_cbranch_scc1 L_bs0_3
s_mul_i32 s47, s45, 221
s_cmp_le_u32 s46, s47
s_cbranch_scc1 L_bs4_5
s_branch L_N78
L_bs4_5:
s_mul_i32 s47, s45, 219
s_cmp_le_u32 s46, s47
s_cbranch_scc1 L_N76
s_branch L_N77
L_bs0_3:
s_mul_i32 s47, s45, 186
s_cmp_le_u32 s46, s47
s_cbranch_scc1 L_bs0_1
s_mul_i32 s47, s45, 202
s_cmp_le_u32 s46, s47
s_cbranch_scc1 L_N64
s_branch L_N72
L_bs0_1:
s_mul_i32 s47, s45, 170
s_cmp_le_u32 s46, s47
s_cbranch_scc1 L_N48
s_branch L_N56
L_short:
v_mov_b32 v27, 0x40000000
v_add_u32 v26, 0, v2
v_cmp_gt_u32 vcc, s59, v26
s_nop 1
v_cndmask_b32 v8, v27, v4, vcc
v_add_u32 v26, 4, v2
v_cmp_gt_u32 vcc, s59, v26
s_nop 1
v_cndmask_b32 v9, v27, v5, vcc
v_add_u32 v26, 8, v2
v_cmp_gt_u32 vcc, s59, v26
s_nop 1
v_cndmask_b32 v10, v27, v6, vcc
v_add_u32 v26, 12, v2
v_cmp_gt_u32 vcc, s59, v26
s_nop 1
v_cndmask_b32 v11, v27, v7, vcc
v_add_u32 v26, 16, v2
v_cmp_gt_u32 vcc, s59, v26
s_nop 1
v_cndmask_b32 v12, v27, v4, vcc
v_add_u32 v26, 20, v2
v_cmp_gt_u32 vcc, s59, v26
s_nop 1
v_cndmask_b32 v13, v27, v5, vcc
v_add_u32 v26, 24, v2
v_cmp_gt_u32 vcc, s59, v26
s_nop 1
v_cndmask_b32 v14, v27, v6, vcc
v_add_u32 v26, 28, v2
v_cmp_gt_u32 vcc, s59, v26
s_nop 1
v_cndmask_b32 v15, v27, v7, vcc
s_branch L_nopre
L_one:
v_mov_b32 v27, 0x40000000
v_add_u32 v26, 0, v2
v_cmp_gt_u32 vcc, s59, v26
s_nop 1
v_cndmask_b32 v8, v27, v4, vcc
v_add_u32 v26, 4, v2
v_cmp_gt_u32 vcc, s59, v26
s_nop 1
v_cndmask_b32 v9, v27, v5, vcc
v_add_u32 v26, 8, v2
v_cmp_gt_u32 vcc, s59, v26
s_nop 1
v_cndmask_b32 v10, v27, v6, vcc
v_add_u32 v26, 12, v2
v_cmp_gt_u32 vcc, s59, v26
s_nop 1
v_cndmask_b32 v11, v27, v7, vcc
v_add_u32 v26, 16, v2
v_cmp_gt_u32 vcc, s59, v26
s_nop 1
v_cndmask_b32 v12, v27, v4, vcc
v_add_u32 v26, 20, v2
v_cmp_gt_u32 vcc, s59, v26
s_nop 1
v_cndmask_b32 v13, v27, v5, vcc
v_add_u32 v26, 24, v2
v_cmp_gt_u32 vcc, s59, v26
s_nop 1
v_cndmask_b32 v14, v27, v6, vcc
v_add_u32 v26, 28, v2
v_cmp_gt_u32 vcc, s59, v26
s_nop 1
v_cndmask_b32 v15, v27, v7, vcc
v_mov_b32 v16, v8
v_mov_b32 v20, v12
v_mov_b32 v17, v9
v_mov_b32 v21, v13
v_mov_b32 v18, v10
v_mov_b32 v22, v14
v_mov_b32 v19, v11
v_mov_b32 v23, v15
s_branch L_U0
L_tail:
s_add_u32 s43, s53, 1
v_readlane_b32 s64, v24, s43
v_readlane_b32 s65, v25, s43
s_add_u32 s43, s53, 2
v_readlane_b32 s66, v24, s43
v_readlane_b32 s67, v25, s43
s_sub_u32 s44, s42, 7
L_tchk:
v_readfirstlane_b32 s94, v32
v_readfirstlane_b32 s95, v33
s_min_i32 s94, s94, s95
s_cmp_ge_i32 s94, s44
s_cbranch_scc1 L_tgo
v_mov_b32 v30, s42
s_waitcnt vmcnt(0)
ds_write_b32 v31, v30
ds_read2_b32 v[32:33], v31 offset0:64 offset1:128
s_waitcnt lgkmcnt(0)
s_branch L_tchk
L_tgo:
s_add_i32 s43, s42, -4
v_mov_b32 v30, s43
s_mov_b32 m0, s54
s_nop 0
buffer_load_dwordx4 v4, s[20:23], s40 offen offset:0 nt lds
s_waitcnt vmcnt(25)
v_add_u32 v30, 1, v30
ds_write_b32 v31, v30
buffer_load_dwordx4 v5, s[20:23], s40 offen offset:1024 nt lds
s_add_u32 s54, s54, 8192
s_cmp_eq_u32 s54, 81920
s_cselect_b32 s54, 0, s54
s_waitcnt vmcnt(25)
buffer_load_dwordx4 v6, s[20:23], s40 offen offset:2048 nt lds
s_waitcnt vmcnt(25)
buffer_load_dwordx4 v7, s[20:23], s40 offen offset:3072 nt lds
s_add_u32 m0, m0, 4096
s_waitcnt vmcnt(25)
buffer_load_dwordx4 v4, s[20:23], s41 offen offset:0 nt lds
s_waitcnt vmcnt(25)
buffer_load_dwordx4 v5, s[20:23], s41 offen offset:1024 nt lds
s_waitcnt vmcnt(25)
buffer_load_dwordx4 v6, s[20:23], s41 offen offset:2048 nt lds
s_waitcnt vmcnt(25)
buffer_load_dwordx4 v7, s[20:23], s41 offen offset:3072 nt lds
s_mov_b32 m0, s54
s_waitcnt vmcnt(25)
buffer_load_dwordx4 v4, s[20:23], s64 offen offset:0 nt lds
s_waitcnt vmcnt(25)
v_add_u32 v30, 1, v30
ds_write_b32 v31, v30
buffer_load_dwordx4 v5, s[20:23], s64 offen offset:1024 nt lds
s_add_u32 s54, s54, 8192
s_cmp_eq_u32 s54, 81920
s_cselect_b32 s54, 0, s54
s_waitcnt vmcnt(25)
buffer_load_dwordx4 v6, s[20:23], s64 offen offset:2048 nt lds
s_waitcnt vmcnt(25)
buffer_load_dwordx4 v7, s[20:23], s64 offen offset:3072 nt lds
s_add_u32 m0, m0, 4096
s_waitcnt vmcnt(25)
buffer_load_dwordx4 v4, s[20:23], s65 offen offset:0 nt lds
s_waitcnt vmcnt(25)
buffer_load_dwordx4 v5, s[20:23], s65 offen offset:1024 nt lds
s_waitcnt vmcnt(25)
buffer_load_dwordx4 v6, s[20:23], s65 offen offset:2048 nt lds
s_waitcnt vmcnt(25)
buffer_load_dwordx4 v7, s[20:23], s65 offen offset:3072 nt lds
s_mov_b32 m0, s54
s_waitcnt vmcnt(25)
buffer_load_dwordx4 v8, s[20:23], s66 offen offset:0 nt lds
s_waitcnt vmcnt(25)
v_add_u32 v30, 1, v30
ds_write_b32 v31, v30
buffer_load_dwordx4 v9, s[20:23], s66 offen offset:1024 nt lds
s_add_u32 s54, s54, 8192
s_cmp_eq_u32 s54, 81920
s_cselect_b32 s54, 0, s54
s_waitcnt vmcnt(25)
buffer_load_dwordx4 v10, s[20:23], s66 offen offset:2048 nt lds
s_waitcnt vmcnt(25)
buffer_load_dwordx4 v11, s[20:23], s66 offen offset:3072 nt lds
s_add_u32 m0, m0, 4096
s_waitcnt vmcnt(25)
buffer_load_dwordx4 v12, s[20:23], s67 offen offset:0 nt lds
s_waitcnt vmcnt(25)
buffer_load_dwordx4 v13, s[20:23], s67 offen offset:1024 nt lds
s_waitcnt vmcnt(25)
buffer_load_dwordx4 v14, s[20:23], s67 offen offset:2048 nt lds
s_waitcnt vmcnt(25)
buffer_load_dwordx4 v15, s[20:23], s67 offen offset:3072 nt lds
s_mov_b32 m0, s54
s_waitcnt vmcnt(25)
L_drain:
s_sub_u32 s43, s61, 5
v_mov_b32 v30, s43
v_add_u32 v30, 1, v30
s_waitcnt vmcnt(32)
ds_write_b32 v31, v30
v_add_u32 v30, 1, v30
s_waitcnt vmcnt(24)
ds_write_b32 v31, v30
v_add_u32 v30, 1, v30
s_waitcnt vmcnt(16)
ds_write_b32 v31, v30
v_add_u32 v30, 1, v30
s_waitcnt vmcnt(8)
ds_write_b32 v31, v30
v_add_u32 v30, 1, v30
s_waitcnt vmcnt(0)
ds_write_b32 v31, v30
s_endpgm
L_cons:
s_and_b32 s100, s2, 5
s_cmp_eq_u32 s100, 5
s_cselect_b32 s100, 2, 0
s_xor_b32 s38, s100, s2
s_and_b32 s37, s38, 31
v_and_b32 v1, 15, v0
v_bfe_u32 v2, v0, 4, 2
v_and_b32 v3, 63, v0
s_mov_b32 s34, 32
s_mov_b32 s35, 0x20000
s_lshr_b32 s55, s3, 7
v_lshlrev_b32 v18, 2, v3
v_add_u32 v18, 151552, v18
s_lshl_b32 s43, s55, 8
s_add_u32 s43, s43, 256
v_add_u32 v19, s43, v18
v_mov_b32 v20, 0
ds_write_b32 v18, v20
ds_write_b32 v19, v20
ds_write_b32 v18, v20 offset:768
ds_write_b32 v19, v20 offset:2304
v_and_b32 v28, 7, v3
v_lshlrev_b32 v28, 2, v28
v_lshrrev_b32 v29, 3, v3
v_lshlrev_b32 v29, 2, v29
v_lshlrev_b32 v4, 4, v2
v_lshl_add_u32 v30, v1, 8, v4
s_lshl_b32 s44, s38, 12
s_mov_b32 s22, 0x100000
s_mov_b32 s23, 0x20000
s_waitcnt lgkmcnt(0)
s_mov_b32 s32, s12
s_mov_b32 s33, s13
buffer_load_dword v28, v28, s[32:35], 0 offen
buffer_load_dword v29, v29, s[32:35], 0 offen
s_lshl_b32 s43, s36, 9
v_lshl_add_u32 v5, v3, 3, s43
global_load_dwordx2 v[100:101], v5, s[10:11]
s_mov_b32 s20, s4
s_mov_b32 s21, s5
buffer_load_dwordx4 v[84:87], v30, s[20:23], s44 offen offset:0
buffer_load_dwordx4 v[88:91], v30, s[20:23], s44 offen offset:64
buffer_load_dwordx4 v[92:95], v30, s[20:23], s44 offen offset:128
buffer_load_dwordx4 v[96:99], v30, s[20:23], s44 offen offset:192
s_barrier
s_add_u32 s24, s14, s44
s_addc_u32 s25, s15, 0
s_mov_b32 s26, 4096
s_mov_b32 s27, 0x20000
v_xor_b32 v4, v2, v1
v_lshlrev_b32 v4, 4, v4
v_lshl_add_u32 v8, v1, 8, v4
v_xor_b32 v9, 64, v8
v_xor_b32 v10, 128, v8
v_xor_b32 v11, 192, v8
v_lshrrev_b32 v4, 2, v3
v_and_b32 v6, 3, v3
v_lshlrev_b32 v6, 2, v6
v_xor_b32 v6, v6, v4
v_lshlrev_b32 v6, 4, v6
v_lshl_add_u32 v12, v4, 8, v6
s_lshl_b32 s43, s55, 5
v_xor_b32 v12, s43, v12
v_xor_b32 v13, 16, v12
v_lshlrev_b32 v32, 3, v3
v_add_u32 v32, 152576, v32
v_lshlrev_b32 v33, 6, v2
v_lshl_add_u32 v33, v1, 8, v33
v_add_u32 v33, s43, v33
s_lshl_b32 s47, s55, 10
s_add_u32 s47, s47, 81920
v_lshl_add_u32 v23, v3, 4, s47
s_lshl_b32 s47, s55, 6
s_add_u32 s47, s47, 147456
v_lshl_add_u32 v34, v1, 2, s47
s_mov_b32 s51, 0xf149f2ca
s_mov_b32 s52, 0
s_mov_b32 s42, s55
s_lshl_b32 s54, s55, 13
s_waitcnt vmcnt(4)
v_add_u32 v7, -1, v28
v_min_u32 v7, 0x7ff, v7
v_lshrrev_b32 v7, 5, v7
v_add_u32 v6, -1, v29
v_min_u32 v6, 0x7ff, v6
v_lshrrev_b32 v6, 5, v6
v_and_b32 v4, 7, v3
v_lshl_add_u32 v7, v7, 3, v4
v_lshrrev_b32 v4, 3, v3
v_lshl_add_u32 v5, v6, 3, v4
v_cmp_gt_u32 s[72:73], v7, v5
v_and_b32 v7, 56, v3
s_lshl_b32 s43, s36, 3
v_lshrrev_b64 v[4:5], v7, s[72:73]
v_and_b32 v4, 0xff, v4
v_bcnt_u32_b32 v4, v4, 0
v_readlane_b32 s49, v6, s43
v_readlane_b32 s56, v4, s43
s_nop 1
s_sub_u32 s57, 7, s56
v_cmp_eq_u32 s[74:75], s57, v4
s_nop 1
s_ff1_i32_b64 s44, s[74:75]
s_lshr_b32 s58, s44, 3
v_readlane_b32 s43, v6, s44
s_nop 1
s_max_u32 s57, s43, s49
s_min_u32 s43, s43, s49
s_sub_u32 s57, s57, s43
s_lshr_b32 s57, s57, 1
s_min_u32 s43, s57, s43
s_cmp_lt_u32 s56, 4
s_cselect_b32 s56, s43, 0
s_cselect_b32 s57, 0, s43
s_sub_u32 s49, s49, s56
s_add_u32 s49, s49, s57
v_readlane_b32 s50, v29, s44
s_lshl_b32 s43, s36, 3
v_readlane_b32 s39, v29, s43
s_lshl_b32 s46, s49, 1
s_add_u32 s46, s46, 1
s_cmp_lt_i32 s50, 1
s_cselect_b32 s50, 0, 0x3e0293ee
s_cmp_lt_i32 s39, 1
s_cselect_b32 s63, 0, 0x3e0293ee
s_sub_u32 s39, s39, 1
s_min_u32 s39, s39, 2047
s_and_b32 s59, s39, 31
s_add_u32 s59, s59, 1
s_cmp_lg_u32 s57, 0
s_cselect_b32 s43, s58, s36
s_lshl_b32 s43, s43, 5
s_or_b32 s58, s43, s37
s_lshl_b32 s43, s58, 1
s_add_u32 s43, s43, s55
s_lshl_b32 s43, s43, 12
s_add_u32 s28, s18, s43
s_addc_u32 s29, s19, 0
s_mov_b32 s30, 2560
s_mov_b32 s31, 0x20000
buffer_load_dword v31, off, s[28:31], 0 offset:2304 sc1
s_lshl_b32 s94, s56, 1
s_add_u32 s94, s94, 16
s_lshr_b32 s95, s39, 5
s_lshl_b32 s95, s95, 1
s_mov_b32 s99, s57
s_cmp_eq_u32 s55, 1
s_cselect_b32 s57, s57, 0
s_cselect_b32 s100, 5, 0
s_min_u32 s100, s100, s46
s_cmp_eq_u32 s57, 0
s_cbranch_scc1 L_noq
s_lshl_b32 s43, s58, 12
buffer_load_dwordx4 v[68:71], v30, s[20:23], s43 offen offset:0
buffer_load_dwordx4 v[72:75], v30, s[20:23], s43 offen offset:64
buffer_load_dwordx4 v[76:79], v30, s[20:23], s43 offen offset:128
buffer_load_dwordx4 v[80:83], v30, s[20:23], s43 offen offset:192
L_noq:
s_cmp_eq_u32 s55, 0
s_cbranch_scc1 L_nosort
v_lshlrev_b32 v104, 1, v3
v_add_u32 v105, 1, v104
v_lshrrev_b32 v102, 7, v100
v_cmp_le_u32 vcc, s94, v104
v_cmp_gt_u32 s[72:73], s95, v104
v_min_u32 v102, 8, v102
s_and_b64 vcc, vcc, s[72:73]
v_cndmask_b32 v102, 63, v102, vcc
v_lshrrev_b32 v103, 7, v101
v_cmp_le_u32 vcc, s94, v105
v_cmp_gt_u32 s[72:73], s95, v105
v_min_u32 v103, 8, v103
s_and_b64 vcc, vcc, s[72:73]
v_cndmask_b32 v103, 63, v103, vcc
v_cmp_eq_u32 s[72:73], 0, v102
v_cmp_eq_u32 s[74:75], 0, v103
v_mov_b32 v106, s94
s_bcnt1_i32_b64 s43, s[72:73]
s_add_u32 s94, s94, s43
v_mbcnt_lo_u32_b32 v106, s72, v106
v_mov_b32 v107, s94
v_mbcnt_hi_u32_b32 v106, s73, v106
v_mbcnt_lo_u32_b32 v107, s74, v107
s_bcnt1_i32_b64 s43, s[74:75]
v_mbcnt_hi_u32_b32 v107, s75, v107
s_add_u32 s94, s94, s43
v_cndmask_b32 v104, v104, v106, s[72:73]
v_cndmask_b32 v105, v105, v107, s[74:75]
v_cmp_eq_u32 s[72:73], 1, v102
v_cmp_eq_u32 s[74:75], 1, v103
v_mov_b32 v106, s94
s_bcnt1_i32_b64 s43, s[72:73]
s_add_u32 s94, s94, s43
v_mbcnt_lo_u32_b32 v106, s72, v106
v_mov_b32 v107, s94
v_mbcnt_hi_u32_b32 v106, s73, v106
v_mbcnt_lo_u32_b32 v107, s74, v107
s_bcnt1_i32_b64 s43, s[74:75]
v_mbcnt_hi_u32_b32 v107, s75, v107
s_add_u32 s94, s94, s43
v_cndmask_b32 v104, v104, v106, s[72:73]
v_cndmask_b32 v105, v105, v107, s[74:75]
v_cmp_eq_u32 s[72:73], 2, v102
v_cmp_eq_u32 s[74:75], 2, v103
v_mov_b32 v106, s94
s_bcnt1_i32_b64 s43, s[72:73]
s_add_u32 s94, s94, s43
v_mbcnt_lo_u32_b32 v106, s72, v106
v_mov_b32 v107, s94
v_mbcnt_hi_u32_b32 v106, s73, v106
v_mbcnt_lo_u32_b32 v107, s74, v107
s_bcnt1_i32_b64 s43, s[74:75]
v_mbcnt_hi_u32_b32 v107, s75, v107
s_add_u32 s94, s94, s43
v_cndmask_b32 v104, v104, v106, s[72:73]
v_cndmask_b32 v105, v105, v107, s[74:75]
v_cmp_eq_u32 s[72:73], 3, v102
v_cmp_eq_u32 s[74:75], 3, v103
v_mov_b32 v106, s94
s_bcnt1_i32_b64 s43, s[72:73]
s_add_u32 s94, s94, s43
v_mbcnt_lo_u32_b32 v106, s72, v106
v_mov_b32 v107, s94
v_mbcnt_hi_u32_b32 v106, s73, v106
v_mbcnt_lo_u32_b32 v107, s74, v107
s_bcnt1_i32_b64 s43, s[74:75]
v_mbcnt_hi_u32_b32 v107, s75, v107
s_add_u32 s94, s94, s43
v_cndmask_b32 v104, v104, v106, s[72:73]
v_cndmask_b32 v105, v105, v107, s[74:75]
v_cmp_eq_u32 s[72:73], 4, v102
v_cmp_eq_u32 s[74:75], 4, v103
v_mov_b32 v106, s94
s_bcnt1_i32_b64 s43, s[72:73]
s_add_u32 s94, s94, s43
v_mbcnt_lo_u32_b32 v106, s72, v106
v_mov_b32 v107, s94
v_mbcnt_hi_u32_b32 v106, s73, v106
v_mbcnt_lo_u32_b32 v107, s74, v107
s_bcnt1_i32_b64 s43, s[74:75]
v_mbcnt_hi_u32_b32 v107, s75, v107
s_add_u32 s94, s94, s43
v_cndmask_b32 v104, v104, v106, s[72:73]
v_cndmask_b32 v105, v105, v107, s[74:75]
v_cmp_eq_u32 s[72:73], 5, v102
v_cmp_eq_u32 s[74:75], 5, v103
v_mov_b32 v106, s94
s_bcnt1_i32_b64 s43, s[72:73]
s_add_u32 s94, s94, s43
v_mbcnt_lo_u32_b32 v106, s72, v106
v_mov_b32 v107, s94
v_mbcnt_hi_u32_b32 v106, s73, v106
v_mbcnt_lo_u32_b32 v107, s74, v107
s_bcnt1_i32_b64 s43, s[74:75]
v_mbcnt_hi_u32_b32 v107, s75, v107
s_add_u32 s94, s94, s43
v_cndmask_b32 v104, v104, v106, s[72:73]
v_cndmask_b32 v105, v105, v107, s[74:75]
v_cmp_eq_u32 s[72:73], 6, v102
v_cmp_eq_u32 s[74:75], 6, v103
v_mov_b32 v106, s94
s_bcnt1_i32_b64 s43, s[72:73]
s_add_u32 s94, s94, s43
v_mbcnt_lo_u32_b32 v106, s72, v106
v_mov_b32 v107, s94
v_mbcnt_hi_u32_b32 v106, s73, v106
v_mbcnt_lo_u32_b32 v107, s74, v107
s_bcnt1_i32_b64 s43, s[74:75]
v_mbcnt_hi_u32_b32 v107, s75, v107
s_add_u32 s94, s94, s43
v_cndmask_b32 v104, v104, v106, s[72:73]
v_cndmask_b32 v105, v105, v107, s[74:75]
v_cmp_eq_u32 s[72:73], 7, v102
v_cmp_eq_u32 s[74:75], 7, v103
v_mov_b32 v106, s94
s_bcnt1_i32_b64 s43, s[72:73]
s_add_u32 s94, s94, s43
v_mbcnt_lo_u32_b32 v106, s72, v106
v_mov_b32 v107, s94
v_mbcnt_hi_u32_b32 v106, s73, v106
v_mbcnt_lo_u32_b32 v107, s74, v107
s_bcnt1_i32_b64 s43, s[74:75]
v_mbcnt_hi_u32_b32 v107, s75, v107
s_add_u32 s94, s94, s43
v_cndmask_b32 v104, v104, v106, s[72:73]
v_cndmask_b32 v105, v105, v107, s[74:75]
v_cmp_eq_u32 s[72:73], 8, v102
v_cmp_eq_u32 s[74:75], 8, v103
v_mov_b32 v106, s94
s_bcnt1_i32_b64 s43, s[72:73]
s_add_u32 s94, s94, s43
v_mbcnt_lo_u32_b32 v106, s72, v106
v_mov_b32 v107, s94
v_mbcnt_hi_u32_b32 v106, s73, v106
v_mbcnt_lo_u32_b32 v107, s74, v107
s_bcnt1_i32_b64 s43, s[74:75]
v_mbcnt_hi_u32_b32 v107, s75, v107
s_add_u32 s94, s94, s43
v_cndmask_b32 v104, v104, v106, s[72:73]
v_cndmask_b32 v105, v105, v107, s[74:75]
v_lshlrev_b32 v104, 2, v104
v_lshlrev_b32 v105, 2, v105
v_add_u32 v104, 154624, v104
v_add_u32 v105, 154624, v105
ds_write_b32 v104, v100
ds_write_b32 v105, v101
v_mov_b32 v106, 1
s_waitcnt lgkmcnt(0)
ds_write_b32 v18, v106 offset:768
L_nosort:
v_lshlrev_b32 v4, 2, v2
v_mov_b32 v7, s51
v_add_u32 v5, 0, v4
v_cmp_gt_u32 vcc, s59, v5
v_mov_b32 v52, 0
s_nop 0
v_cndmask_b32 v60, v7, v52, vcc
v_add_u32 v5, 1, v4
v_cmp_gt_u32 vcc, s59, v5
v_mov_b32 v53, 0
s_nop 0
v_cndmask_b32 v61, v7, v53, vcc
v_add_u32 v5, 2, v4
v_cmp_gt_u32 vcc, s59, v5
v_mov_b32 v54, 0
s_nop 0
v_cndmask_b32 v62, v7, v54, vcc
v_add_u32 v5, 3, v4
v_cmp_gt_u32 vcc, s59, v5
v_mov_b32 v55, 0
s_nop 0
v_cndmask_b32 v63, v7, v55, vcc
v_add_u32 v5, 16, v4
v_cmp_gt_u32 vcc, s59, v5
v_mov_b32 v56, 0
s_nop 0
v_cndmask_b32 v64, v7, v56, vcc
v_add_u32 v5, 17, v4
v_cmp_gt_u32 vcc, s59, v5
v_mov_b32 v57, 0
s_nop 0
v_cndmask_b32 v65, v7, v57, vcc
v_add_u32 v5, 18, v4
v_cmp_gt_u32 vcc, s59, v5
v_mov_b32 v58, 0
s_nop 0
v_cndmask_b32 v66, v7, v58, vcc
v_add_u32 v5, 19, v4
v_cmp_gt_u32 vcc, s59, v5
v_mov_b32 v59, 0
s_nop 0
v_cndmask_b32 v67, v7, v59, vcc
s_sub_u32 s62, s49, 12
s_cmp_eq_u32 s56, 0
s_cselect_b32 s62, 1000, s62
s_cselect_b32 s98, 0, 1
v_mov_b32 v40, s51
v_mov_b32 v41, 0
v_mov_b32 v180, 0
v_mov_b32 v181, 0
v_mov_b32 v182, 0
v_mov_b32 v183, 0
v_mov_b32 v184, 0
v_mov_b32 v185, 0
v_mov_b32 v186, 0
v_mov_b32 v187, 0
v_mov_b32 v188, 0
v_mov_b32 v189, 0
v_mov_b32 v190, 0
v_mov_b32 v191, 0
v_mov_b32 v192, 0
v_mov_b32 v193, 0
v_mov_b32 v194, 0
v_mov_b32 v195, 0
v_mov_b32 v116, 0
v_mov_b32 v117, 0
v_mov_b32 v118, 0
v_mov_b32 v119, 0
v_mov_b32 v120, 0
v_mov_b32 v121, 0
v_mov_b32 v122, 0
v_mov_b32 v123, 0
v_mov_b32 v124, 0
v_mov_b32 v125, 0
v_mov_b32 v126, 0
v_mov_b32 v127, 0
v_mov_b32 v128, 0
v_mov_b32 v129, 0
v_mov_b32 v130, 0
v_mov_b32 v131, 0
v_mov_b32 v132, 0
v_mov_b32 v133, 0
v_mov_b32 v134, 0
v_mov_b32 v135, 0
v_mov_b32 v136, 0
v_mov_b32 v137, 0
v_mov_b32 v138, 0
v_mov_b32 v139, 0
v_mov_b32 v140, 0
v_mov_b32 v141, 0
v_mov_b32 v142, 0
v_mov_b32 v143, 0
v_mov_b32 v144, 0
v_mov_b32 v145, 0
v_mov_b32 v146, 0
v_mov_b32 v147, 0
s_waitcnt vmcnt(0)
v_add_u32 v31, 1, v31
s_getreg_b32 s43, hwreg(HW_REG_XCC_ID, 0, 4)
s_lshl_b32 s43, s43, 28
v_add_u32 v35, s43, v31
s_cmp_eq_u32 s56, 0
s_cbranch_scc1 L_nopub
v_lshlrev_b32 v5, 2, v3
s_mov_b64 exec, 0xffffffff
buffer_store_dword v35, v5, s[28:31], 0 offen offset:2432
s_mov_b64 exec, -1
L_nopub:
s_lshl_b32 s61, s57, 1
s_sub_u32 s61, s61, 1
s_cmp_lg_u32 s57, 0
s_cbranch_scc1 L_init1
L_own1:
v_mov_b32 v68, v84
v_mov_b32 v69, v85
v_mov_b32 v70, v86
v_mov_b32 v71, v87
v_mov_b32 v72, v88
v_mov_b32 v73, v89
v_mov_b32 v74, v90
v_mov_b32 v75, v91
v_mov_b32 v76, v92
v_mov_b32 v77, v93
v_mov_b32 v78, v94
v_mov_b32 v79, v95
v_mov_b32 v80, v96
v_mov_b32 v81, v97
v_mov_b32 v82, v98
v_mov_b32 v83, v99
s_mov_b32 s50, s63
s_mov_b32 s61, s49
s_mov_b32 s57, 0
L_init1:
v_mov_b32 v21, s51
v_mov_b32 v22, 0
s_cmp_gt_u32 s42, s61
s_cbranch_scc1 L_pass2
L_loop1:
s_add_u32 s53, s42, 1
s_max_u32 s44, s53, s100
v_add_u32 v14, s54, v8
v_add_u32 v15, s54, v9
v_add_u32 v16, s54, v10
v_add_u32 v17, s54, v11
s_cmp_eq_u32 s42, s49
s_cbranch_scc1 L_mask
L_pollK:
s_cmp_ge_i32 s52, s44
s_cbranch_scc1 L_goK
ds_read_b32 v20, v18
s_waitcnt lgkmcnt(0)
v_readfirstlane_b32 s52, v20
s_branch L_pollK
L_goK:
ds_read_b128 v[148:151], v14 offset:0
ds_read_b128 v[152:155], v14 offset:4096
ds_read_b128 v[156:159], v15 offset:0
ds_read_b128 v[160:163], v15 offset:4096
ds_read_b128 v[164:167], v16 offset:0
ds_read_b128 v[168:171], v16 offset:4096
ds_read_b128 v[172:175], v17 offset:0
ds_read_b128 v[176:179], v17 offset:4096
v_mov_b32 v20, s53
s_waitcnt lgkmcnt(6)
v_mfma_f32_16x16x32_bf16 v[100:103], v[148:151], v[68:71], v[52:55]
v_mfma_f32_16x16x32_bf16 v[104:107], v[152:155], v[68:71], v[56:59]
s_waitcnt lgkmcnt(4)
v_mfma_f32_16x16x32_bf16 v[100:103], v[156:159], v[72:75], v[100:103]
v_mfma_f32_16x16x32_bf16 v[104:107], v[160:163], v[72:75], v[104:107]
s_waitcnt lgkmcnt(2)
v_mfma_f32_16x16x32_bf16 v[100:103], v[164:167], v[76:79], v[100:103]
v_mfma_f32_16x16x32_bf16 v[104:107], v[168:171], v[76:79], v[104:107]
s_waitcnt lgkmcnt(0)
ds_write_b32 v19, v20
v_mfma_f32_16x16x32_bf16 v[100:103], v[172:175], v[80:83], v[100:103]
v_mfma_f32_16x16x32_bf16 v[104:107], v[176:179], v[80:83], v[104:107]
s_nop 7
v_max3_f32 v4, v100, v101, v102
v_max3_f32 v5, v104, v105, v106
v_max3_f32 v4, v4, v103, v107
v_max_f32 v4, v4, v5
v_mov_b32 v5, v4
s_nop 1
v_permlane32_swap_b32 v4, v5
v_max_f32 v4, v4, v5
v_mov_b32 v5, v4
s_nop 1
v_permlane16_swap_b32 v4, v5
v_max_f32 v4, v4, v5
v_mul_f32 v4, s50, v4
v_max_f32 v4, v4, v21
v_sub_f32 v5, v21, v4
v_exp_f32 v24, v5
v_mov_b32 v21, v4
v_fma_f32 v100, v100, s50, -v21
v_fma_f32 v101, v101, s50, -v21
v_fma_f32 v102, v102, s50, -v21
v_fma_f32 v103, v103, s50, -v21
v_fma_f32 v104, v104, s50, -v21
v_fma_f32 v105, v105, s50, -v21
v_fma_f32 v106, v106, s50, -v21
v_fma_f32 v107, v107, s50, -v21
ds_write_b32 v34, v24
v_exp_f32 v100, v100
v_exp_f32 v101, v101
v_exp_f32 v102, v102
v_exp_f32 v103, v103
v_exp_f32 v104, v104
v_exp_f32 v105, v105
v_exp_f32 v106, v106
v_exp_f32 v107, v107
v_mul_f32 v22, v22, v24
v_cvt_pk_bf16_f32 v108, v100, v101
v_cvt_pk_bf16_f32 v109, v102, v103
v_cvt_pk_bf16_f32 v110, v104, v105
v_cvt_pk_bf16_f32 v111, v106, v107
v_add_f32 v4, v100, v101
v_add_f32 v5, v102, v103
ds_write_b128 v23, v[108:111]
v_add_f32 v6, v104, v105
v_add_f32 v7, v106, v107
v_add_f32 v4, v4, v5
v_add_f32 v6, v6, v7
v_add_f32 v4, v4, v6
v_add_f32 v22, v22, v4
v_add_u32 v23, 2048, v23
v_add_u32 v34, 128, v34
s_add_u32 s54, s54, 16384
s_sub_u32 s43, s54, 81920
s_cselect_b32 s54, s54, s43
s_add_u32 s42, s42, 2
s_cmp_le_u32 s42, s61
s_cbranch_scc1 L_loop1
s_cmp_eq_u32 s57, 0
s_cbranch_scc1 L_pass2
v_mov_b32 v5, v22
v_mov_b32 v24, v21
s_nop 0
v_permlane32_swap_b32 v22, v5
v_add_f32 v22, v22, v5
v_mov_b32 v5, v22
s_nop 1
v_permlane16_swap_b32 v22, v5
v_add_f32 v25, v22, v5
ds_write_b64 v32, v[24:25] offset:1024
s_branch L_own1
L_pass2:
v_mov_b32 v5, v22
v_mov_b32 v24, v21
s_nop 0
v_permlane32_swap_b32 v22, v5
v_add_f32 v22, v22, v5
v_mov_b32 v5, v22
s_nop 1
v_permlane16_swap_b32 v22, v5
v_add_f32 v25, v22, v5
s_lshl_b32 s43, s55, 9
v_add_u32 v6, s43, v32
ds_write_b64 v6, v[24:25]
v_mov_b32 v20, 1
v_xor_b32 v7, 768, v19
s_add_u32 s43, s49, 1
s_add_u32 s53, s43, 1
s_mul_i32 s44, s43, 205
s_lshr_b32 s44, s44, 11
s_mul_i32 s44, s44, 10
s_sub_u32 s43, s43, s44
s_lshl_b32 s54, s43, 13
s_waitcnt lgkmcnt(0)
ds_write_b32 v19, v20 offset:2304
v_lshlrev_b32 v23, 4, v3
v_add_u32 v23, 81920, v23
v_lshlrev_b32 v34, 2, v1
v_add_u32 v34, 147456, v34
s_mov_b32 s42, 0
s_lshl_b32 s96, s99, 1
s_cbranch_scc0 L_p1w
buffer_load_dword v68, off, s[28:31], 0 offset:2432 sc1
L_p1w:
ds_read_b32 v4, v7 offset:2304
s_waitcnt lgkmcnt(0)
v_readfirstlane_b32 s43, v4
s_cmp_eq_u32 s43, 0
s_cbranch_scc1 L_p1w
ds_read_b64 v[36:37], v32
ds_read_b64 v[38:39], v32 offset:512
ds_read_b64 v[48:49], v32 offset:1024
ds_read_b32 v24, v34
ds_read_b128 v[108:111], v23
v_mov_b32 v28, 0
v_mov_b32 v50, v31
v_mov_b32 v51, v31
s_waitcnt lgkmcnt(2)
v_max3_f32 v4, v36, v38, v40
v_sub_f32 v42, v36, v4
v_sub_f32 v44, v38, v4
v_sub_f32 v46, v40, v4
v_exp_f32 v42, v42
v_exp_f32 v44, v44
v_exp_f32 v46, v46
v_mul_f32 v4, v42, v37
v_fmac_f32 v4, v44, v39
v_fmac_f32 v4, v46, v41
v_rcp_f32 v4, v4
s_nop 0
v_mul_f32 v42, v42, v4
v_mul_f32 v44, v44, v4
v_mul_f32 v46, v46, v4
L_b0:
s_cmp_ge_i32 s42, s62
s_cbranch_scc1 L_ec0
L_br0:
v_add_u32 v14, s54, v12
v_add_u32 v15, s54, v13
v_add_u32 v23, 1024, v23
v_add_u32 v34, 64, v34
s_waitcnt lgkmcnt(0)
v_readfirstlane_b32 s52, v28
v_pk_mul_f32 v[116:117], v[116:117], v[24:25] op_sel_hi:[1,0]
v_pk_mul_f32 v[118:119], v[118:119], v[24:25] op_sel_hi:[1,0]
v_pk_mul_f32 v[120:121], v[120:121], v[24:25] op_sel_hi:[1,0]
v_pk_mul_f32 v[122:123], v[122:123], v[24:25] op_sel_hi:[1,0]
v_pk_mul_f32 v[124:125], v[124:125], v[24:25] op_sel_hi:[1,0]
v_pk_mul_f32 v[126:127], v[126:127], v[24:25] op_sel_hi:[1,0]
v_pk_mul_f32 v[128:129], v[128:129], v[24:25] op_sel_hi:[1,0]
v_pk_mul_f32 v[130:131], v[130:131], v[24:25] op_sel_hi:[1,0]
L_pollV0:
s_cmp_ge_i32 s52, s53
s_cbranch_scc1 L_goV0
ds_read_b32 v20, v18
s_waitcnt lgkmcnt(0)
v_readfirstlane_b32 s52, v20
s_branch L_pollV0
L_goV0:
ds_read_b64_tr_b16 v[148:149], v14 offset:0
ds_read_b64_tr_b16 v[150:151], v14 offset:4096
ds_read_b64_tr_b16 v[152:153], v14 offset:8
ds_read_b64_tr_b16 v[154:155], v14 offset:4104
ds_read_b64_tr_b16 v[156:157], v15 offset:0
ds_read_b64_tr_b16 v[158:159], v15 offset:4096
ds_read_b64_tr_b16 v[160:161], v15 offset:8
ds_read_b64_tr_b16 v[162:163], v15 offset:4104
ds_read_b32 v26, v34
ds_read_b128 v[112:115], v23
v_mov_b32 v20, s53
s_add_u32 s54, s54, 8192
s_cmp_eq_u32 s54, 81920
s_cselect_b32 s54, 0, s54
s_add_u32 s53, s53, 1
s_add_u32 s42, s42, 1
s_waitcnt lgkmcnt(8)
v_mfma_f32_16x16x32_bf16 v[116:119], v[148:151], v[108:111], v[116:119]
s_waitcnt lgkmcnt(6)
v_mfma_f32_16x16x32_bf16 v[120:123], v[152:155], v[108:111], v[120:123]
s_waitcnt lgkmcnt(4)
v_mfma_f32_16x16x32_bf16 v[124:127], v[156:159], v[108:111], v[124:127]
s_waitcnt lgkmcnt(2)
ds_write_b32 v19, v20
ds_read_b32 v28, v18
v_mfma_f32_16x16x32_bf16 v[128:131], v[160:163], v[108:111], v[128:131]
s_cmp_gt_u32 s42, s49
s_cbranch_scc1 L_epi0
L_b1:
s_cmp_ge_i32 s42, s62
s_cbranch_scc1 L_ec1
L_br1:
v_add_u32 v14, s54, v12
v_add_u32 v15, s54, v13
v_add_u32 v23, 1024, v23
v_add_u32 v34, 64, v34
s_waitcnt lgkmcnt(0)
v_readfirstlane_b32 s52, v28
v_pk_mul_f32 v[132:133], v[132:133], v[26:27] op_sel_hi:[1,0]
v_pk_mul_f32 v[134:135], v[134:135], v[26:27] op_sel_hi:[1,0]
v_pk_mul_f32 v[136:137], v[136:137], v[26:27] op_sel_hi:[1,0]
v_pk_mul_f32 v[138:139], v[138:139], v[26:27] op_sel_hi:[1,0]
v_pk_mul_f32 v[140:141], v[140:141], v[26:27] op_sel_hi:[1,0]
v_pk_mul_f32 v[142:143], v[142:143], v[26:27] op_sel_hi:[1,0]
v_pk_mul_f32 v[144:145], v[144:145], v[26:27] op_sel_hi:[1,0]
v_pk_mul_f32 v[146:147], v[146:147], v[26:27] op_sel_hi:[1,0]
L_pollV1:
s_cmp_ge_i32 s52, s53
s_cbranch_scc1 L_goV1
ds_read_b32 v20, v18
s_waitcnt lgkmcnt(0)
v_readfirstlane_b32 s52, v20
s_branch L_pollV1
L_goV1:
ds_read_b64_tr_b16 v[148:149], v14 offset:0
ds_read_b64_tr_b16 v[150:151], v14 offset:4096
ds_read_b64_tr_b16 v[152:153], v14 offset:8
ds_read_b64_tr_b16 v[154:155], v14 offset:4104
ds_read_b64_tr_b16 v[156:157], v15 offset:0
ds_read_b64_tr_b16 v[158:159], v15 offset:4096
ds_read_b64_tr_b16 v[160:161], v15 offset:8
ds_read_b64_tr_b16 v[162:163], v15 offset:4104
ds_read_b32 v24, v34
ds_read_b128 v[108:111], v23
v_mov_b32 v20, s53
s_add_u32 s54, s54, 8192
s_cmp_eq_u32 s54, 81920
s_cselect_b32 s54, 0, s54
s_add_u32 s53, s53, 1
s_add_u32 s42, s42, 1
s_waitcnt lgkmcnt(8)
v_mfma_f32_16x16x32_bf16 v[132:135], v[148:151], v[112:115], v[132:135]
s_waitcnt lgkmcnt(6)
v_mfma_f32_16x16x32_bf16 v[136:139], v[152:155], v[112:115], v[136:139]
s_waitcnt lgkmcnt(4)
v_mfma_f32_16x16x32_bf16 v[140:143], v[156:159], v[112:115], v[140:143]
s_waitcnt lgkmcnt(2)
ds_write_b32 v19, v20
ds_read_b32 v28, v18
v_mfma_f32_16x16x32_bf16 v[144:147], v[160:163], v[112:115], v[144:147]
s_cmp_eq_u32 s42, s96
s_cbranch_scc1 L_flush
L_fr:
s_cmp_le_u32 s42, s49
s_cbranch_scc1 L_b0
L_epi1:
s_cmp_lg_u32 s98, 0
s_cbranch_scc1 L_fin1
v_pk_fma_f32 v[116:117], v[116:117], v[42:43], v[180:181] op_sel_hi:[1,0,1]
v_pk_fma_f32 v[118:119], v[118:119], v[42:43], v[182:183] op_sel_hi:[1,0,1]
v_pk_fma_f32 v[120:121], v[120:121], v[42:43], v[184:185] op_sel_hi:[1,0,1]
v_pk_fma_f32 v[122:123], v[122:123], v[42:43], v[186:187] op_sel_hi:[1,0,1]
v_pk_fma_f32 v[124:125], v[124:125], v[42:43], v[188:189] op_sel_hi:[1,0,1]
v_pk_fma_f32 v[126:127], v[126:127], v[42:43], v[190:191] op_sel_hi:[1,0,1]
v_pk_fma_f32 v[128:129], v[128:129], v[42:43], v[192:193] op_sel_hi:[1,0,1]
v_pk_fma_f32 v[130:131], v[130:131], v[42:43], v[194:195] op_sel_hi:[1,0,1]
v_pk_fma_f32 v[116:117], v[132:133], v[44:45], v[116:117] op_sel_hi:[1,0,1]
v_pk_fma_f32 v[118:119], v[134:135], v[44:45], v[118:119] op_sel_hi:[1,0,1]
v_pk_fma_f32 v[120:121], v[136:137], v[44:45], v[120:121] op_sel_hi:[1,0,1]
v_pk_fma_f32 v[122:123], v[138:139], v[44:45], v[122:123] op_sel_hi:[1,0,1]
v_cvt_pk_bf16_f32 v100, v116, v117
v_cvt_pk_bf16_f32 v101, v118, v119
v_cvt_pk_bf16_f32 v102, v120, v121
v_cvt_pk_bf16_f32 v103, v122, v123
buffer_store_dwordx4 v[100:103], v33, s[24:27], 0 offen offset:0
v_pk_fma_f32 v[124:125], v[140:141], v[44:45], v[124:125] op_sel_hi:[1,0,1]
v_pk_fma_f32 v[126:127], v[142:143], v[44:45], v[126:127] op_sel_hi:[1,0,1]
v_pk_fma_f32 v[128:129], v[144:145], v[44:45], v[128:129] op_sel_hi:[1,0,1]
v_pk_fma_f32 v[130:131], v[146:147], v[44:45], v[130:131] op_sel_hi:[1,0,1]
v_cvt_pk_bf16_f32 v104, v124, v125
v_cvt_pk_bf16_f32 v105, v126, v127
v_cvt_pk_bf16_f32 v106, v128, v129
v_cvt_pk_bf16_f32 v107, v130, v131
buffer_store_dwordx4 v[104:107], v33, s[24:27], 0 offen offset:16
s_endpgm
L_epi0:
s_cmp_lg_u32 s98, 0
s_cbranch_scc1 L_fin0
v_pk_fma_f32 v[132:133], v[132:133], v[44:45], v[180:181] op_sel_hi:[1,0,1]
v_pk_fma_f32 v[134:135], v[134:135], v[44:45], v[182:183] op_sel_hi:[1,0,1]
v_pk_fma_f32 v[136:137], v[136:137], v[44:45], v[184:185] op_sel_hi:[1,0,1]
v_pk_fma_f32 v[138:139], v[138:139], v[44:45], v[186:187] op_sel_hi:[1,0,1]
v_pk_fma_f32 v[140:141], v[140:141], v[44:45], v[188:189] op_sel_hi:[1,0,1]
v_pk_fma_f32 v[142:143], v[142:143], v[44:45], v[190:191] op_sel_hi:[1,0,1]
v_pk_fma_f32 v[144:145], v[144:145], v[44:45], v[192:193] op_sel_hi:[1,0,1]
v_pk_fma_f32 v[146:147], v[146:147], v[44:45], v[194:195] op_sel_hi:[1,0,1]
v_pk_fma_f32 v[132:133], v[116:117], v[42:43], v[132:133] op_sel_hi:[1,0,1]
v_pk_fma_f32 v[134:135], v[118:119], v[42:43], v[134:135] op_sel_hi:[1,0,1]
v_pk_fma_f32 v[136:137], v[120:121], v[42:43], v[136:137] op_sel_hi:[1,0,1]
v_pk_fma_f32 v[138:139], v[122:123], v[42:43], v[138:139] op_sel_hi:[1,0,1]
v_cvt_pk_bf16_f32 v100, v132, v133
v_cvt_pk_bf16_f32 v101, v134, v135
v_cvt_pk_bf16_f32 v102, v136, v137
v_cvt_pk_bf16_f32 v103, v138, v139
buffer_store_dwordx4 v[100:103], v33, s[24:27], 0 offen offset:0
v_pk_fma_f32 v[140:141], v[124:125], v[42:43], v[140:141] op_sel_hi:[1,0,1]
v_pk_fma_f32 v[142:143], v[126:127], v[42:43], v[142:143] op_sel_hi:[1,0,1]
v_pk_fma_f32 v[144:145], v[128:129], v[42:43], v[144:145] op_sel_hi:[1,0,1]
v_pk_fma_f32 v[146:147], v[130:131], v[42:43], v[146:147] op_sel_hi:[1,0,1]
v_cvt_pk_bf16_f32 v104, v140, v141
v_cvt_pk_bf16_f32 v105, v142, v143
v_cvt_pk_bf16_f32 v106, v144, v145
v_cvt_pk_bf16_f32 v107, v146, v147
buffer_store_dwordx4 v[104:107], v33, s[24:27], 0 offen offset:16
s_endpgm
L_mask:
v_mov_b32 v52, v60
v_mov_b32 v53, v61
v_mov_b32 v54, v62
v_mov_b32 v55, v63
v_mov_b32 v56, v64
v_mov_b32 v57, v65
v_mov_b32 v58, v66
v_mov_b32 v59, v67
s_branch L_pollK
L_ec0:
s_mov_b32 s97, 0
s_branch L_ev
L_ec1:
s_mov_b32 s97, 1
s_branch L_ev
L_fin0:
s_mov_b32 s97, 2
s_branch L_ev
L_fin1:
s_mov_b32 s97, 3
L_ev:
s_waitcnt vmcnt(0)
s_cmp_lt_u32 s98, 4
s_cbranch_scc1 L_merge
v_lshlrev_b32 v4, 4, v3
s_mov_b64 exec, 0xffff
s_cmp_eq_u32 s98, 5
s_cbranch_scc1 L_e0far
buffer_store_dwordx4 v[48:51], v4, s[28:31], 0 offen offset:2048
s_branch L_e0
L_e0far:
buffer_store_dwordx4 v[48:51], v4, s[28:31], 0 offen offset:2048 sc1
L_e0:
s_mov_b64 exec, -1
L_edone:
s_mov_b32 s98, 0
s_movk_i32 s62, 1000
L_ret:
s_cmp_eq_u32 s97, 0
s_cbranch_scc1 L_br0
s_cmp_eq_u32 s97, 1
s_cbranch_scc1 L_br1
s_cmp_eq_u32 s97, 2
s_cbranch_scc1 L_epi0
s_branch L_epi1
L_flush:
v_lshlrev_b32 v4, 4, v3
s_add_u32 s62, s42, 2
s_mov_b32 s98, 4
s_waitcnt vmcnt(0)
v_cmp_ne_u32 vcc, v35, v68
s_nop 2
v_cvt_pk_bf16_f32 v84, v132, v133
v_cvt_pk_bf16_f32 v85, v134, v135
v_cvt_pk_bf16_f32 v86, v136, v137
v_cvt_pk_bf16_f32 v87, v138, v139
v_cvt_pk_bf16_f32 v88, v140, v141
v_cvt_pk_bf16_f32 v89, v142, v143
v_cvt_pk_bf16_f32 v90, v144, v145
v_cvt_pk_bf16_f32 v91, v146, v147
v_mov_b32 v132, 0
v_mov_b32 v133, 0
v_mov_b32 v134, 0
v_mov_b32 v135, 0
v_mov_b32 v136, 0
v_mov_b32 v137, 0
v_mov_b32 v138, 0
v_mov_b32 v139, 0
v_mov_b32 v140, 0
v_mov_b32 v141, 0
v_mov_b32 v142, 0
v_mov_b32 v143, 0
v_mov_b32 v144, 0
v_mov_b32 v145, 0
v_mov_b32 v146, 0
v_mov_b32 v147, 0
s_cbranch_vccz L_flush_near
s_mov_b32 s98, 5
buffer_store_dwordx4 v[84:87], v4, s[28:31], 0 offen offset:0 sc1
buffer_store_dwordx4 v[88:91], v4, s[28:31], 0 offen offset:1024 sc1
s_branch L_fr
L_flush_near:
buffer_store_dwordx4 v[84:87], v4, s[28:31], 0 offen offset:0
buffer_store_dwordx4 v[88:91], v4, s[28:31], 0 offen offset:1024
s_branch L_fr
L_merge:
s_add_u32 s62, s42, 2
s_cmp_eq_u32 s98, 3
s_cbranch_scc1 L_m2
s_cmp_eq_u32 s98, 1
s_cbranch_scc1 L_m0
v_cmp_ne_u32 vcc, v31, v50
v_lshlrev_b32 v4, 4, v3
s_nop 3
s_cbranch_vccz L_m1
s_sleep 2
L_m0:
v_lshlrev_b32 v6, 4, v1
s_waitcnt lgkmcnt(0)
buffer_load_dwordx4 v[48:51], v6, s[28:31], 0 offen offset:2048 sc1
s_mov_b32 s98, 2
s_branch L_ret
L_m1:
buffer_load_dwordx4 v[68:71], v4, s[28:31], 0 offen offset:0 sc1
buffer_load_dwordx4 v[72:75], v4, s[28:31], 0 offen offset:1024 sc1
s_mov_b32 s98, 3
s_branch L_ret
L_m2:
v_lshlrev_b32 v6, 2, v3
v_mov_b32 v40, v48
v_mov_b32 v41, v49
s_mov_b64 exec, 0xffffffff
buffer_store_dword v31, v6, s[28:31], 0 offen offset:2304
s_mov_b64 exec, -1
v_max3_f32 v4, v36, v38, v40
v_sub_f32 v42, v36, v4
v_sub_f32 v44, v38, v4
v_sub_f32 v46, v40, v4
v_exp_f32 v42, v42
v_exp_f32 v44, v44
v_exp_f32 v46, v46
v_mul_f32 v4, v42, v37
v_fmac_f32 v4, v44, v39
v_fmac_f32 v4, v46, v41
v_rcp_f32 v4, v4
s_nop 0
v_mul_f32 v42, v42, v4
v_mul_f32 v44, v44, v4
v_mul_f32 v46, v46, v4
v_lshlrev_b32 v180, 16, v68
v_and_b32 v181, 0xffff0000, v68
v_lshlrev_b32 v182, 16, v69
v_and_b32 v183, 0xffff0000, v69
v_lshlrev_b32 v184, 16, v70
v_and_b32 v185, 0xffff0000, v70
v_lshlrev_b32 v186, 16, v71
v_and_b32 v187, 0xffff0000, v71
v_lshlrev_b32 v188, 16, v72
v_and_b32 v189, 0xffff0000, v72
v_lshlrev_b32 v190, 16, v73
v_and_b32 v191, 0xffff0000, v73
v_lshlrev_b32 v192, 16, v74
v_and_b32 v193, 0xffff0000, v74
v_lshlrev_b32 v194, 16, v75
v_and_b32 v195, 0xffff0000, v75
v_pk_mul_f32 v[180:181], v[180:181], v[46:47] op_sel_hi:[1,0]
v_pk_mul_f32 v[182:183], v[182:183], v[46:47] op_sel_hi:[1,0]
v_pk_mul_f32 v[184:185], v[184:185], v[46:47] op_sel_hi:[1,0]
v_pk_mul_f32 v[186:187], v[186:187], v[46:47] op_sel_hi:[1,0]
v_pk_mul_f32 v[188:189], v[188:189], v[46:47] op_sel_hi:[1,0]
v_pk_mul_f32 v[190:191], v[190:191], v[46:47] op_sel_hi:[1,0]
v_pk_mul_f32 v[192:193], v[192:193], v[46:47] op_sel_hi:[1,0]
v_pk_mul_f32 v[194:195], v[194:195], v[46:47] op_sel_hi:[1,0]
s_branch L_edone
L_N2104:
s_add_i32 s43, s42, -4
v_mov_b32 v30, s43
s_branch L_go2104
L_top2104:
L_chk2104:
s_waitcnt lgkmcnt(0)
v_readfirstlane_b32 s94, v32
v_readfirstlane_b32 s95, v33
s_min_i32 s48, s95, s94
s_cmp_gt_i32 s48, s44
s_cbranch_scc1 L_ok2104
ds_read2_b32 v[32:33], v31 offset0:64 offset1:128
s_branch L_chk2104
L_ok2104:
s_cmp_eq_u32 s42, s62
s_cbranch_scc1 L_evt
L_go2104:
s_mov_b32 m0, s54
s_nop 0
L_first2104:
buffer_load_dwordx4 v16, s[20:23], s40 offen offset:0 nt lds
v_cndmask_b32 v20, v4, v12, s[72:73]
v_cndmask_b32 v21, v5, v13, s[72:73]
v_cndmask_b32 v22, v6, v14, s[72:73]
v_cndmask_b32 v23, v7, v15, s[72:73]
s_add_u32 s54, s54, 8192
s_cmp_eq_u32 s54, 81920
s_cselect_b32 s54, 0, s54
s_waitcnt vmcnt(25)
v_add_u32 v30, 1, v30
ds_write_b32 v31, v30
buffer_load_dwordx4 v17, s[20:23], s40 offen offset:1024 nt lds
s_add_u32 s42, s42, 1
s_add_u32 s53, s53, 1
s_cmp_eq_u32 s42, s50
s_cselect_b32 s53, 0, s53
ds_read2_b32 v[32:33], v31 offset0:64 offset1:128
s_waitcnt vmcnt(25)
buffer_load_dwordx4 v18, s[20:23], s40 offen offset:2048 nt lds
v_readlane_b32 s56, v24, s53
v_readlane_b32 s57, v25, s53
s_cmp_eq_u32 s53, s49
s_cselect_b64 s[72:73], -1, 0
s_waitcnt vmcnt(25)
buffer_load_dwordx4 v19, s[20:23], s40 offen offset:3072 nt lds
s_add_u32 m0, m0, 4096
s_sub_u32 s44, s42, 10
s_waitcnt vmcnt(25)
buffer_load_dwordx4 v20, s[20:23], s41 offen offset:0 nt lds
s_waitcnt lgkmcnt(0)
v_readfirstlane_b32 s94, v32
v_readfirstlane_b32 s95, v33
s_waitcnt vmcnt(25)
buffer_load_dwordx4 v21, s[20:23], s41 offen offset:1024 nt lds
s_min_i32 s48, s95, s94
s_cmp_gt_i32 s48, s44
s_cselect_b32 s48, s62, s42
s_waitcnt vmcnt(25)
buffer_load_dwordx4 v22, s[20:23], s41 offen offset:2048 nt lds
v_cndmask_b32 v16, v4, v8, s[72:73]
v_cndmask_b32 v17, v5, v9, s[72:73]
v_cndmask_b32 v18, v6, v10, s[72:73]
v_cndmask_b32 v19, v7, v11, s[72:73]
s_waitcnt vmcnt(25)
buffer_load_dwordx4 v23, s[20:23], s41 offen offset:3072 nt lds
s_cmp_ge_u32 s42, s50
s_cselect_b32 s20, s8, s6
s_cselect_b32 s21, s9, s7
s_mov_b32 s40, s56
s_mov_b32 s41, s57
s_mov_b32 m0, s54
s_cmp_lg_u32 s48, s42
s_waitcnt vmcnt(25)
s_cbranch_scc1 L_first2104
s_branch L_top2104
L_N48:
s_add_i32 s43, s42, -2
v_mov_b32 v30, s43
s_branch L_go48
L_top48:
L_chk48:
s_waitcnt lgkmcnt(0)
v_readfirstlane_b32 s94, v32
v_readfirstlane_b32 s95, v33
s_min_i32 s48, s95, s94
s_cmp_gt_i32 s48, s44
s_cbranch_scc1 L_ok48
ds_read2_b32 v[32:33], v31 offset0:64 offset1:128
s_branch L_chk48
L_ok48:
s_cmp_eq_u32 s42, s62
s_cbranch_scc1 L_evt
L_go48:
s_mov_b32 m0, s54
s_nop 0
L_first48:
buffer_load_dwordx4 v16, s[20:23], s40 offen offset:0 nt lds
v_cndmask_b32 v20, v4, v12, s[72:73]
v_cndmask_b32 v21, v5, v13, s[72:73]
v_cndmask_b32 v22, v6, v14, s[72:73]
v_cndmask_b32 v23, v7, v15, s[72:73]
s_add_u32 s54, s54, 8192
s_cmp_eq_u32 s54, 81920
s_cselect_b32 s54, 0, s54
s_waitcnt vmcnt(11)
buffer_load_dwordx4 v17, s[20:23], s40 offen offset:1024 nt lds
s_add_u32 s42, s42, 1
s_add_u32 s53, s53, 1
s_cmp_eq_u32 s42, s50
s_cselect_b32 s53, 0, s53
ds_read2_b32 v[32:33], v31 offset0:64 offset1:128
s_waitcnt vmcnt(11)
buffer_load_dwordx4 v18, s[20:23], s40 offen offset:2048 nt lds
v_readlane_b32 s56, v24, s53
v_readlane_b32 s57, v25, s53
s_cmp_eq_u32 s53, s49
s_cselect_b64 s[72:73], -1, 0
s_waitcnt vmcnt(11)
v_add_u32 v30, 1, v30
ds_write_b32 v31, v30
buffer_load_dwordx4 v19, s[20:23], s40 offen offset:3072 nt lds
s_add_u32 m0, m0, 4096
s_sub_u32 s44, s42, 10
s_waitcnt vmcnt(11)
buffer_load_dwordx4 v20, s[20:23], s41 offen offset:0 nt lds
s_waitcnt lgkmcnt(0)
v_readfirstlane_b32 s94, v32
v_readfirstlane_b32 s95, v33
s_waitcnt vmcnt(11)
buffer_load_dwordx4 v21, s[20:23], s41 offen offset:1024 nt lds
s_min_i32 s48, s95, s94
s_cmp_gt_i32 s48, s44
s_cselect_b32 s48, s62, s42
s_waitcnt vmcnt(11)
buffer_load_dwordx4 v22, s[20:23], s41 offen offset:2048 nt lds
v_cndmask_b32 v16, v4, v8, s[72:73]
v_cndmask_b32 v17, v5, v9, s[72:73]
v_cndmask_b32 v18, v6, v10, s[72:73]
v_cndmask_b32 v19, v7, v11, s[72:73]
s_waitcnt vmcnt(11)
buffer_load_dwordx4 v23, s[20:23], s41 offen offset:3072 nt lds
s_cmp_ge_u32 s42, s50
s_cselect_b32 s20, s8, s6
s_cselect_b32 s21, s9, s7
s_mov_b32 s40, s56
s_mov_b32 s41, s57
s_mov_b32 m0, s54
s_cmp_lg_u32 s48, s42
s_waitcnt vmcnt(11)
s_cbranch_scc1 L_first48
s_branch L_top48
L_N56:
s_add_i32 s43, s42, -2
v_mov_b32 v30, s43
s_branch L_go56
L_top56:
L_chk56:
s_waitcnt lgkmcnt(0)
v_readfirstlane_b32 s94, v32
v_readfirstlane_b32 s95, v33
s_min_i32 s48, s95, s94
s_cmp_gt_i32 s48, s44
s_cbranch_scc1 L_ok56
ds_read2_b32 v[32:33], v31 offset0:64 offset1:128
s_branch L_chk56
L_ok56:
s_cmp_eq_u32 s42, s62
s_cbranch_scc1 L_evt
L_go56:
s_mov_b32 m0, s54
s_nop 0
L_first56:
buffer_load_dwordx4 v16, s[20:23], s40 offen offset:0 nt lds
v_cndmask_b32 v20, v4, v12, s[72:73]
v_cndmask_b32 v21, v5, v13, s[72:73]
v_cndmask_b32 v22, v6, v14, s[72:73]
v_cndmask_b32 v23, v7, v15, s[72:73]
s_add_u32 s54, s54, 8192
s_cmp_eq_u32 s54, 81920
s_cselect_b32 s54, 0, s54
s_waitcnt vmcnt(13)
buffer_load_dwordx4 v17, s[20:23], s40 offen offset:1024 nt lds
s_add_u32 s42, s42, 1
s_add_u32 s53, s53, 1
s_cmp_eq_u32 s42, s50
s_cselect_b32 s53, 0, s53
ds_read2_b32 v[32:33], v31 offset0:64 offset1:128
s_waitcnt vmcnt(13)
buffer_load_dwordx4 v18, s[20:23], s40 offen offset:2048 nt lds
v_readlane_b32 s56, v24, s53
v_readlane_b32 s57, v25, s53
s_cmp_eq_u32 s53, s49
s_cselect_b64 s[72:73], -1, 0
s_waitcnt vmcnt(13)
buffer_load_dwordx4 v19, s[20:23], s40 offen offset:3072 nt lds
s_add_u32 m0, m0, 4096
s_sub_u32 s44, s42, 10
s_waitcnt vmcnt(13)
buffer_load_dwordx4 v20, s[20:23], s41 offen offset:0 nt lds
s_waitcnt lgkmcnt(0)
v_readfirstlane_b32 s94, v32
v_readfirstlane_b32 s95, v33
s_waitcnt vmcnt(13)
v_add_u32 v30, 1, v30
ds_write_b32 v31, v30
buffer_load_dwordx4 v21, s[20:23], s41 offen offset:1024 nt lds
s_min_i32 s48, s95, s94
s_cmp_gt_i32 s48, s44
s_cselect_b32 s48, s62, s42
s_waitcnt vmcnt(13)
buffer_load_dwordx4 v22, s[20:23], s41 offen offset:2048 nt lds
v_cndmask_b32 v16, v4, v8, s[72:73]
v_cndmask_b32 v17, v5, v9, s[72:73]
v_cndmask_b32 v18, v6, v10, s[72:73]
v_cndmask_b32 v19, v7, v11, s[72:73]
s_waitcnt vmcnt(13)
buffer_load_dwordx4 v23, s[20:23], s41 offen offset:3072 nt lds
s_cmp_ge_u32 s42, s50
s_cselect_b32 s20, s8, s6
s_cselect_b32 s21, s9, s7
s_mov_b32 s40, s56
s_mov_b32 s41, s57
s_mov_b32 m0, s54
s_cmp_lg_u32 s48, s42
s_waitcnt vmcnt(13)
s_cbranch_scc1 L_first56
s_branch L_top56
L_N64:
s_add_i32 s43, s42, -2
v_mov_b32 v30, s43
s_branch L_go64
L_top64:
L_chk64:
s_waitcnt lgkmcnt(0)
v_readfirstlane_b32 s94, v32
v_readfirstlane_b32 s95, v33
s_min_i32 s48, s95, s94
s_cmp_gt_i32 s48, s44
s_cbranch_scc1 L_ok64
ds_read2_b32 v[32:33], v31 offset0:64 offset1:128
s_branch L_chk64
L_ok64:
s_cmp_eq_u32 s42, s62
s_cbranch_scc1 L_evt
L_go64:
s_mov_b32 m0, s54
s_nop 0
L_first64:
buffer_load_dwordx4 v16, s[20:23], s40 offen offset:0 nt lds
v_cndmask_b32 v20, v4, v12, s[72:73]
v_cndmask_b32 v21, v5, v13, s[72:73]
v_cndmask_b32 v22, v6, v14, s[72:73]
v_cndmask_b32 v23, v7, v15, s[72:73]
s_add_u32 s54, s54, 8192
s_cmp_eq_u32 s54, 81920
s_cselect_b32 s54, 0, s54
s_waitcnt vmcnt(15)
buffer_load_dwordx4 v17, s[20:23], s40 offen offset:1024 nt lds
s_add_u32 s42, s42, 1
s_add_u32 s53, s53, 1
s_cmp_eq_u32 s42, s50
s_cselect_b32 s53, 0, s53
ds_read2_b32 v[32:33], v31 offset0:64 offset1:128
s_waitcnt vmcnt(15)
buffer_load_dwordx4 v18, s[20:23], s40 offen offset:2048 nt lds
v_readlane_b32 s56, v24, s53
v_readlane_b32 s57, v25, s53
s_cmp_eq_u32 s53, s49
s_cselect_b64 s[72:73], -1, 0
s_waitcnt vmcnt(15)
buffer_load_dwordx4 v19, s[20:23], s40 offen offset:3072 nt lds
s_add_u32 m0, m0, 4096
s_sub_u32 s44, s42, 10
s_waitcnt vmcnt(15)
buffer_load_dwordx4 v20, s[20:23], s41 offen offset:0 nt lds
s_waitcnt lgkmcnt(0)
v_readfirstlane_b32 s94, v32
v_readfirstlane_b32 s95, v33
s_waitcnt vmcnt(15)
buffer_load_dwordx4 v21, s[20:23], s41 offen offset:1024 nt lds
s_min_i32 s48, s95, s94
s_cmp_gt_i32 s48, s44
s_cselect_b32 s48, s62, s42
s_waitcnt vmcnt(15)
buffer_load_dwordx4 v22, s[20:23], s41 offen offset:2048 nt lds
v_cndmask_b32 v16, v4, v8, s[72:73]
v_cndmask_b32 v17, v5, v9, s[72:73]
v_cndmask_b32 v18, v6, v10, s[72:73]
v_cndmask_b32 v19, v7, v11, s[72:73]
s_waitcnt vmcnt(15)
v_add_u32 v30, 1, v30
ds_write_b32 v31, v30
buffer_load_dwordx4 v23, s[20:23], s41 offen offset:3072 nt lds
s_cmp_ge_u32 s42, s50
s_cselect_b32 s20, s8, s6
s_cselect_b32 s21, s9, s7
s_mov_b32 s40, s56
s_mov_b32 s41, s57
s_mov_b32 m0, s54
s_cmp_lg_u32 s48, s42
s_waitcnt vmcnt(15)
s_cbranch_scc1 L_first64
s_branch L_top64
L_N72:
s_add_i32 s43, s42, -3
v_mov_b32 v30, s43
s_branch L_go72
L_top72:
L_chk72:
s_waitcnt lgkmcnt(0)
v_readfirstlane_b32 s94, v32
v_readfirstlane_b32 s95, v33
s_min_i32 s48, s95, s94
s_cmp_gt_i32 s48, s44
s_cbranch_scc1 L_ok72
ds_read2_b32 v[32:33], v31 offset0:64 offset1:128
s_branch L_chk72
L_ok72:
s_cmp_eq_u32 s42, s62
s_cbranch_scc1 L_evt
L_go72:
s_mov_b32 m0, s54
s_nop 0
L_first72:
buffer_load_dwordx4 v16, s[20:23], s40 offen offset:0 nt lds
v_cndmask_b32 v20, v4, v12, s[72:73]
v_cndmask_b32 v21, v5, v13, s[72:73]
v_cndmask_b32 v22, v6, v14, s[72:73]
v_cndmask_b32 v23, v7, v15, s[72:73]
s_add_u32 s54, s54, 8192
s_cmp_eq_u32 s54, 81920
s_cselect_b32 s54, 0, s54
s_waitcnt vmcnt(17)
v_add_u32 v30, 1, v30
ds_write_b32 v31, v30
buffer_load_dwordx4 v17, s[20:23], s40 offen offset:1024 nt lds
s_add_u32 s42, s42, 1
s_add_u32 s53, s53, 1
s_cmp_eq_u32 s42, s50
s_cselect_b32 s53, 0, s53
ds_read2_b32 v[32:33], v31 offset0:64 offset1:128
s_waitcnt vmcnt(17)
buffer_load_dwordx4 v18, s[20:23], s40 offen offset:2048 nt lds
v_readlane_b32 s56, v24, s53
v_readlane_b32 s57, v25, s53
s_cmp_eq_u32 s53, s49
s_cselect_b64 s[72:73], -1, 0
s_waitcnt vmcnt(17)
buffer_load_dwordx4 v19, s[20:23], s40 offen offset:3072 nt lds
s_add_u32 m0, m0, 4096
s_sub_u32 s44, s42, 10
s_waitcnt vmcnt(17)
buffer_load_dwordx4 v20, s[20:23], s41 offen offset:0 nt lds
s_waitcnt lgkmcnt(0)
v_readfirstlane_b32 s94, v32
v_readfirstlane_b32 s95, v33
s_waitcnt vmcnt(17)
buffer_load_dwordx4 v21, s[20:23], s41 offen offset:1024 nt lds
s_min_i32 s48, s95, s94
s_cmp_gt_i32 s48, s44
s_cselect_b32 s48, s62, s42
s_waitcnt vmcnt(17)
buffer_load_dwordx4 v22, s[20:23], s41 offen offset:2048 nt lds
v_cndmask_b32 v16, v4, v8, s[72:73]
v_cndmask_b32 v17, v5, v9, s[72:73]
v_cndmask_b32 v18, v6, v10, s[72:73]
v_cndmask_b32 v19, v7, v11, s[72:73]
s_waitcnt vmcnt(17)
buffer_load_dwordx4 v23, s[20:23], s41 offen offset:3072 nt lds
s_cmp_ge_u32 s42, s50
s_cselect_b32 s20, s8, s6
s_cselect_b32 s21, s9, s7
s_mov_b32 s40, s56
s_mov_b32 s41, s57
s_mov_b32 m0, s54
s_cmp_lg_u32 s48, s42
s_waitcnt vmcnt(17)
s_cbranch_scc1 L_first72
s_branch L_top72
L_N76:
s_add_i32 s43, s42, -3
v_mov_b32 v30, s43
s_branch L_go76
L_top76:
L_chk76:
s_waitcnt lgkmcnt(0)
v_readfirstlane_b32 s94, v32
v_readfirstlane_b32 s95, v33
s_min_i32 s48, s95, s94
s_cmp_gt_i32 s48, s44
s_cbranch_scc1 L_ok76
ds_read2_b32 v[32:33], v31 offset0:64 offset1:128
s_branch L_chk76
L_ok76:
s_cmp_eq_u32 s42, s62
s_cbranch_scc1 L_evt
L_go76:
s_mov_b32 m0, s54
s_nop 0
L_first76:
buffer_load_dwordx4 v16, s[20:23], s40 offen offset:0 nt lds
v_cndmask_b32 v20, v4, v12, s[72:73]
v_cndmask_b32 v21, v5, v13, s[72:73]
v_cndmask_b32 v22, v6, v14, s[72:73]
v_cndmask_b32 v23, v7, v15, s[72:73]
s_add_u32 s54, s54, 8192
s_cmp_eq_u32 s54, 81920
s_cselect_b32 s54, 0, s54
s_waitcnt vmcnt(18)
buffer_load_dwordx4 v17, s[20:23], s40 offen offset:1024 nt lds
s_add_u32 s42, s42, 1
s_add_u32 s53, s53, 1
s_cmp_eq_u32 s42, s50
s_cselect_b32 s53, 0, s53
ds_read2_b32 v[32:33], v31 offset0:64 offset1:128
s_waitcnt vmcnt(18)
v_add_u32 v30, 1, v30
ds_write_b32 v31, v30
buffer_load_dwordx4 v18, s[20:23], s40 offen offset:2048 nt lds
v_readlane_b32 s56, v24, s53
v_readlane_b32 s57, v25, s53
s_cmp_eq_u32 s53, s49
s_cselect_b64 s[72:73], -1, 0
s_waitcnt vmcnt(18)
buffer_load_dwordx4 v19, s[20:23], s40 offen offset:3072 nt lds
s_add_u32 m0, m0, 4096
s_sub_u32 s44, s42, 10
s_waitcnt vmcnt(18)
buffer_load_dwordx4 v20, s[20:23], s41 offen offset:0 nt lds
s_waitcnt lgkmcnt(0)
v_readfirstlane_b32 s94, v32
v_readfirstlane_b32 s95, v33
s_waitcnt vmcnt(18)
buffer_load_dwordx4 v21, s[20:23], s41 offen offset:1024 nt lds
s_min_i32 s48, s95, s94
s_cmp_gt_i32 s48, s44
s_cselect_b32 s48, s62, s42
s_waitcnt vmcnt(18)
buffer_load_dwordx4 v22, s[20:23], s41 offen offset:2048 nt lds
v_cndmask_b32 v16, v4, v8, s[72:73]
v_cndmask_b32 v17, v5, v9, s[72:73]
v_cndmask_b32 v18, v6, v10, s[72:73]
v_cndmask_b32 v19, v7, v11, s[72:73]
s_waitcnt vmcnt(18)
buffer_load_dwordx4 v23, s[20:23], s41 offen offset:3072 nt lds
s_cmp_ge_u32 s42, s50
s_cselect_b32 s20, s8, s6
s_cselect_b32 s21, s9, s7
s_mov_b32 s40, s56
s_mov_b32 s41, s57
s_mov_b32 m0, s54
s_cmp_lg_u32 s48, s42
s_waitcnt vmcnt(18)
s_cbranch_scc1 L_first76
s_branch L_top76
L_N77:
s_add_i32 s43, s42, -3
v_mov_b32 v30, s43
s_branch L_go77
L_top77:
L_chk77:
s_waitcnt lgkmcnt(0)
v_readfirstlane_b32 s94, v32
v_readfirstlane_b32 s95, v33
s_min_i32 s48, s95, s94
s_cmp_gt_i32 s48, s44
s_cbranch_scc1 L_ok77
ds_read2_b32 v[32:33], v31 offset0:64 offset1:128
s_branch L_chk77
L_ok77:
s_cmp_eq_u32 s42, s62
s_cbranch_scc1 L_evt
L_go77:
s_mov_b32 m0, s54
s_nop 0
L_first77:
buffer_load_dwordx4 v16, s[20:23], s40 offen offset:0 nt lds
v_cndmask_b32 v20, v4, v12, s[72:73]
v_cndmask_b32 v21, v5, v13, s[72:73]
v_cndmask_b32 v22, v6, v14, s[72:73]
v_cndmask_b32 v23, v7, v15, s[72:73]
s_add_u32 s54, s54, 8192
s_cmp_eq_u32 s54, 81920
s_cselect_b32 s54, 0, s54
s_waitcnt vmcnt(18)
buffer_load_dwordx4 v17, s[20:23], s40 offen offset:1024 nt lds
s_add_u32 s42, s42, 1
s_add_u32 s53, s53, 1
s_cmp_eq_u32 s42, s50
s_cselect_b32 s53, 0, s53
ds_read2_b32 v[32:33], v31 offset0:64 offset1:128
s_waitcnt vmcnt(18)
v_add_u32 v30, 1, v30
ds_write_b32 v31, v30
buffer_load_dwordx4 v18, s[20:23], s40 offen offset:2048 nt lds
v_readlane_b32 s56, v24, s53
v_readlane_b32 s57, v25, s53
s_cmp_eq_u32 s53, s49
s_cselect_b64 s[72:73], -1, 0
s_waitcnt vmcnt(18)
buffer_load_dwordx4 v19, s[20:23], s40 offen offset:3072 nt lds
s_add_u32 m0, m0, 4096
s_sub_u32 s44, s42, 10
s_waitcnt vmcnt(19)
buffer_load_dwordx4 v20, s[20:23], s41 offen offset:0 nt lds
s_waitcnt lgkmcnt(0)
v_readfirstlane_b32 s94, v32
v_readfirstlane_b32 s95, v33
s_waitcnt vmcnt(18)
buffer_load_dwordx4 v21, s[20:23], s41 offen offset:1024 nt lds
s_min_i32 s48, s95, s94
s_cmp_gt_i32 s48, s44
s_cselect_b32 s48, s62, s42
s_waitcnt vmcnt(18)
buffer_load_dwordx4 v22, s[20:23], s41 offen offset:2048 nt lds
v_cndmask_b32 v16, v4, v8, s[72:73]
v_cndmask_b32 v17, v5, v9, s[72:73]
v_cndmask_b32 v18, v6, v10, s[72:73]
v_cndmask_b32 v19, v7, v11, s[72:73]
s_waitcnt vmcnt(18)
buffer_load_dwordx4 v23, s[20:23], s41 offen offset:3072 nt lds
s_cmp_ge_u32 s42, s50
s_cselect_b32 s20, s8, s6
s_cselect_b32 s21, s9, s7
s_mov_b32 s40, s56
s_mov_b32 s41, s57
s_mov_b32 m0, s54
s_cmp_lg_u32 s48, s42
s_waitcnt vmcnt(19)
s_cbranch_scc1 L_first77
s_branch L_top77
L_N78:
s_add_i32 s43, s42, -3
v_mov_b32 v30, s43
s_branch L_go78
L_top78:
L_chk78:
s_waitcnt lgkmcnt(0)
v_readfirstlane_b32 s94, v32
v_readfirstlane_b32 s95, v33
s_min_i32 s48, s95, s94
s_cmp_gt_i32 s48, s44
s_cbranch_scc1 L_ok78
ds_read2_b32 v[32:33], v31 offset0:64 offset1:128
s_branch L_chk78
L_ok78:
s_cmp_eq_u32 s42, s62
s_cbranch_scc1 L_evt
L_go78:
s_mov_b32 m0, s54
s_nop 0
L_first78:
buffer_load_dwordx4 v16, s[20:23], s40 offen offset:0 nt lds
v_cndmask_b32 v20, v4, v12, s[72:73]
v_cndmask_b32 v21, v5, v13, s[72:73]
v_cndmask_b32 v22, v6, v14, s[72:73]
v_cndmask_b32 v23, v7, v15, s[72:73]
s_add_u32 s54, s54, 8192
s_cmp_eq_u32 s54, 81920
s_cselect_b32 s54, 0, s54
s_waitcnt vmcnt(18)
buffer_load_dwordx4 v17, s[20:23], s40 offen offset:1024 nt lds
s_add_u32 s42, s42, 1
s_add_u32 s53, s53, 1
s_cmp_eq_u32 s42, s50
s_cselect_b32 s53, 0, s53
ds_read2_b32 v[32:33], v31 offset0:64 offset1:128
s_waitcnt vmcnt(19)
buffer_load_dwordx4 v18, s[20:23], s40 offen offset:2048 nt lds
v_readlane_b32 s56, v24, s53
v_readlane_b32 s57, v25, s53
s_cmp_eq_u32 s53, s49
s_cselect_b64 s[72:73], -1, 0
s_waitcnt vmcnt(18)
v_add_u32 v30, 1, v30
ds_write_b32 v31, v30
buffer_load_dwordx4 v19, s[20:23], s40 offen offset:3072 nt lds
s_add_u32 m0, m0, 4096
s_sub_u32 s44, s42, 10
s_waitcnt vmcnt(19)
buffer_load_dwordx4 v20, s[20:23], s41 offen offset:0 nt lds
s_waitcnt lgkmcnt(0)
v_readfirstlane_b32 s94, v32
v_readfirstlane_b32 s95, v33
s_waitcnt vmcnt(18)
buffer_load_dwordx4 v21, s[20:23], s41 offen offset:1024 nt lds
s_min_i32 s48, s95, s94
s_cmp_gt_i32 s48, s44
s_cselect_b32 s48, s62, s42
s_waitcnt vmcnt(19)
buffer_load_dwordx4 v22, s[20:23], s41 offen offset:2048 nt lds
v_cndmask_b32 v16, v4, v8, s[72:73]
v_cndmask_b32 v17, v5, v9, s[72:73]
v_cndmask_b32 v18, v6, v10, s[72:73]
v_cndmask_b32 v19, v7, v11, s[72:73]
s_waitcnt vmcnt(18)
buffer_load_dwordx4 v23, s[20:23], s41 offen offset:3072 nt lds
s_cmp_ge_u32 s42, s50
s_cselect_b32 s20, s8, s6
s_cselect_b32 s21, s9, s7
s_mov_b32 s40, s56
s_mov_b32 s41, s57
s_mov_b32 m0, s54
s_cmp_lg_u32 s48, s42
s_waitcnt vmcnt(19)
s_cbranch_scc1 L_first78
s_branch L_top78
L_N79:
s_add_i32 s43, s42, -3
v_mov_b32 v30, s43
s_branch L_go79
L_top79:
L_chk79:
s_waitcnt lgkmcnt(0)
v_readfirstlane_b32 s94, v32
v_readfirstlane_b32 s95, v33
s_min_i32 s48, s95, s94
s_cmp_gt_i32 s48, s44
s_cbranch_scc1 L_ok79
ds_read2_b32 v[32:33], v31 offset0:64 offset1:128
s_branch L_chk79
L_ok79:
s_cmp_eq_u32 s42, s62
s_cbranch_scc1 L_evt
L_go79:
s_mov_b32 m0, s54
s_nop 0
L_first79:
buffer_load_dwordx4 v16, s[20:23], s40 offen offset:0 nt lds
v_cndmask_b32 v20, v4, v12, s[72:73]
v_cndmask_b32 v21, v5, v13, s[72:73]
v_cndmask_b32 v22, v6, v14, s[72:73]
v_cndmask_b32 v23, v7, v15, s[72:73]
s_add_u32 s54, s54, 8192
s_cmp_eq_u32 s54, 81920
s_cselect_b32 s54, 0, s54
s_waitcnt vmcnt(18)
buffer_load_dwordx4 v17, s[20:23], s40 offen offset:1024 nt lds
s_add_u32 s42, s42, 1
s_add_u32 s53, s53, 1
s_cmp_eq_u32 s42, s50
s_cselect_b32 s53, 0, s53
ds_read2_b32 v[32:33], v31 offset0:64 offset1:128
s_waitcnt vmcnt(19)
buffer_load_dwordx4 v18, s[20:23], s40 offen offset:2048 nt lds
v_readlane_b32 s56, v24, s53
v_readlane_b32 s57, v25, s53
s_cmp_eq_u32 s53, s49
s_cselect_b64 s[72:73], -1, 0
s_waitcnt vmcnt(19)
v_add_u32 v30, 1, v30
ds_write_b32 v31, v30
buffer_load_dwordx4 v19, s[20:23], s40 offen offset:3072 nt lds
s_add_u32 m0, m0, 4096
s_sub_u32 s44, s42, 10
s_waitcnt vmcnt(19)
buffer_load_dwordx4 v20, s[20:23], s41 offen offset:0 nt lds
s_waitcnt lgkmcnt(0)
v_readfirstlane_b32 s94, v32
v_readfirstlane_b32 s95, v33
s_waitcnt vmcnt(18)
buffer_load_dwordx4 v21, s[20:23], s41 offen offset:1024 nt lds
s_min_i32 s48, s95, s94
s_cmp_gt_i32 s48, s44
s_cselect_b32 s48, s62, s42
s_waitcnt vmcnt(19)
buffer_load_dwordx4 v22, s[20:23], s41 offen offset:2048 nt lds
v_cndmask_b32 v16, v4, v8, s[72:73]
v_cndmask_b32 v17, v5, v9, s[72:73]
v_cndmask_b32 v18, v6, v10, s[72:73]
v_cndmask_b32 v19, v7, v11, s[72:73]
s_waitcnt vmcnt(19)
buffer_load_dwordx4 v23, s[20:23], s41 offen offset:3072 nt lds
s_cmp_ge_u32 s42, s50
s_cselect_b32 s20, s8, s6
s_cselect_b32 s21, s9, s7
s_mov_b32 s40, s56
s_mov_b32 s41, s57
s_mov_b32 m0, s54
s_cmp_lg_u32 s48, s42
s_waitcnt vmcnt(19)
s_cbranch_scc1 L_first79
s_branch L_top79
L_N80:
s_add_i32 s43, s42, -3
v_mov_b32 v30, s43
s_branch L_go80
L_top80:
L_chk80:
s_waitcnt lgkmcnt(0)
v_readfirstlane_b32 s94, v32
v_readfirstlane_b32 s95, v33
s_min_i32 s48, s95, s94
s_cmp_gt_i32 s48, s44
s_cbranch_scc1 L_ok80
ds_read2_b32 v[32:33], v31 offset0:64 offset1:128
s_branch L_chk80
L_ok80:
s_cmp_eq_u32 s42, s62
s_cbranch_scc1 L_evt
L_go80:
s_mov_b32 m0, s54
s_nop 0
L_first80:
buffer_load_dwordx4 v16, s[20:23], s40 offen offset:0 nt lds
v_cndmask_b32 v20, v4, v12, s[72:73]
v_cndmask_b32 v21, v5, v13, s[72:73]
v_cndmask_b32 v22, v6, v14, s[72:73]
v_cndmask_b32 v23, v7, v15, s[72:73]
s_add_u32 s54, s54, 8192
s_cmp_eq_u32 s54, 81920
s_cselect_b32 s54, 0, s54
s_waitcnt vmcnt(19)
buffer_load_dwordx4 v17, s[20:23], s40 offen offset:1024 nt lds
s_add_u32 s42, s42, 1
s_add_u32 s53, s53, 1
s_cmp_eq_u32 s42, s50
s_cselect_b32 s53, 0, s53
ds_read2_b32 v[32:33], v31 offset0:64 offset1:128
s_waitcnt vmcnt(19)
buffer_load_dwordx4 v18, s[20:23], s40 offen offset:2048 nt lds
v_readlane_b32 s56, v24, s53
v_readlane_b32 s57, v25, s53
s_cmp_eq_u32 s53, s49
s_cselect_b64 s[72:73], -1, 0
s_waitcnt vmcnt(19)
v_add_u32 v30, 1, v30
ds_write_b32 v31, v30
buffer_load_dwordx4 v19, s[20:23], s40 offen offset:3072 nt lds
s_add_u32 m0, m0, 4096
s_sub_u32 s44, s42, 10
s_waitcnt vmcnt(19)
buffer_load_dwordx4 v20, s[20:23], s41 offen offset:0 nt lds
s_waitcnt lgkmcnt(0)
v_readfirstlane_b32 s94, v32
v_readfirstlane_b32 s95, v33
s_waitcnt vmcnt(19)
buffer_load_dwordx4 v21, s[20:23], s41 offen offset:1024 nt lds
s_min_i32 s48, s95, s94
s_cmp_gt_i32 s48, s44
s_cselect_b32 s48, s62, s42
s_waitcnt vmcnt(19)
buffer_load_dwordx4 v22, s[20:23], s41 offen offset:2048 nt lds
v_cndmask_b32 v16, v4, v8, s[72:73]
v_cndmask_b32 v17, v5, v9, s[72:73]
v_cndmask_b32 v18, v6, v10, s[72:73]
v_cndmask_b32 v19, v7, v11, s[72:73]
s_waitcnt vmcnt(19)
buffer_load_dwordx4 v23, s[20:23], s41 offen offset:3072 nt lds
s_cmp_ge_u32 s42, s50
s_cselect_b32 s20, s8, s6
s_cselect_b32 s21, s9, s7
s_mov_b32 s40, s56
s_mov_b32 s41, s57
s_mov_b32 m0, s54
s_cmp_lg_u32 s48, s42
s_waitcnt vmcnt(19)
s_cbranch_scc1 L_first80
s_branch L_top80
L_N81:
s_add_i32 s43, s42, -3
v_mov_b32 v30, s43
s_branch L_go81
L_top81:
L_chk81:
s_waitcnt lgkmcnt(0)
v_readfirstlane_b32 s94, v32
v_readfirstlane_b32 s95, v33
s_min_i32 s48, s95, s94
s_cmp_gt_i32 s48, s44
s_cbranch_scc1 L_ok81
ds_read2_b32 v[32:33], v31 offset0:64 offset1:128
s_branch L_chk81
L_ok81:
s_cmp_eq_u32 s42, s62
s_cbranch_scc1 L_evt
L_go81:
s_mov_b32 m0, s54
s_nop 0
L_first81:
buffer_load_dwordx4 v16, s[20:23], s40 offen offset:0 nt lds
v_cndmask_b32 v20, v4, v12, s[72:73]
v_cndmask_b32 v21, v5, v13, s[72:73]
v_cndmask_b32 v22, v6, v14, s[72:73]
v_cndmask_b32 v23, v7, v15, s[72:73]
s_add_u32 s54, s54, 8192
s_cmp_eq_u32 s54, 81920
s_cselect_b32 s54, 0, s54
s_waitcnt vmcnt(19)
buffer_load_dwordx4 v17, s[20:23], s40 offen offset:1024 nt lds
s_add_u32 s42, s42, 1
s_add_u32 s53, s53, 1
s_cmp_eq_u32 s42, s50
s_cselect_b32 s53, 0, s53
ds_read2_b32 v[32:33], v31 offset0:64 offset1:128
s_waitcnt vmcnt(19)
buffer_load_dwordx4 v18, s[20:23], s40 offen offset:2048 nt lds
v_readlane_b32 s56, v24, s53
v_readlane_b32 s57, v25, s53
s_cmp_eq_u32 s53, s49
s_cselect_b64 s[72:73], -1, 0
s_waitcnt vmcnt(19)
v_add_u32 v30, 1, v30
ds_write_b32 v31, v30
buffer_load_dwordx4 v19, s[20:23], s40 offen offset:3072 nt lds
s_add_u32 m0, m0, 4096
s_sub_u32 s44, s42, 10
s_waitcnt vmcnt(20)
buffer_load_dwordx4 v20, s[20:23], s41 offen offset:0 nt lds
s_waitcnt lgkmcnt(0)
v_readfirstlane_b32 s94, v32
v_readfirstlane_b32 s95, v33
s_waitcnt vmcnt(19)
buffer_load_dwordx4 v21, s[20:23], s41 offen offset:1024 nt lds
s_min_i32 s48, s95, s94
s_cmp_gt_i32 s48, s44
s_cselect_b32 s48, s62, s42
s_waitcnt vmcnt(19)
buffer_load_dwordx4 v22, s[20:23], s41 offen offset:2048 nt lds
v_cndmask_b32 v16, v4, v8, s[72:73]
v_cndmask_b32 v17, v5, v9, s[72:73]
v_cndmask_b32 v18, v6, v10, s[72:73]
v_cndmask_b32 v19, v7, v11, s[72:73]
s_waitcnt vmcnt(19)
buffer_load_dwordx4 v23, s[20:23], s41 offen offset:3072 nt lds
s_cmp_ge_u32 s42, s50
s_cselect_b32 s20, s8, s6
s_cselect_b32 s21, s9, s7
s_mov_b32 s40, s56
s_mov_b32 s41, s57
s_mov_b32 m0, s54
s_cmp_lg_u32 s48, s42
s_waitcnt vmcnt(20)
s_cbranch_scc1 L_first81
s_branch L_top81
L_N82:
s_add_i32 s43, s42, -3
v_mov_b32 v30, s43
s_branch L_go82
L_top82:
L_chk82:
s_waitcnt lgkmcnt(0)
v_readfirstlane_b32 s94, v32
v_readfirstlane_b32 s95, v33
s_min_i32 s48, s95, s94
s_cmp_gt_i32 s48, s44
s_cbranch_scc1 L_ok82
ds_read2_b32 v[32:33], v31 offset0:64 offset1:128
s_branch L_chk82
L_ok82:
s_cmp_eq_u32 s42, s62
s_cbranch_scc1 L_evt
L_go82:
s_mov_b32 m0, s54
s_nop 0
L_first82:
buffer_load_dwordx4 v16, s[20:23], s40 offen offset:0 nt lds
v_cndmask_b32 v20, v4, v12, s[72:73]
v_cndmask_b32 v21, v5, v13, s[72:73]
v_cndmask_b32 v22, v6, v14, s[72:73]
v_cndmask_b32 v23, v7, v15, s[72:73]
s_add_u32 s54, s54, 8192
s_cmp_eq_u32 s54, 81920
s_cselect_b32 s54, 0, s54
s_waitcnt vmcnt(19)
buffer_load_dwordx4 v17, s[20:23], s40 offen offset:1024 nt lds
s_add_u32 s42, s42, 1
s_add_u32 s53, s53, 1
s_cmp_eq_u32 s42, s50
s_cselect_b32 s53, 0, s53
ds_read2_b32 v[32:33], v31 offset0:64 offset1:128
s_waitcnt vmcnt(20)
buffer_load_dwordx4 v18, s[20:23], s40 offen offset:2048 nt lds
v_readlane_b32 s56, v24, s53
v_readlane_b32 s57, v25, s53
s_cmp_eq_u32 s53, s49
s_cselect_b64 s[72:73], -1, 0
s_waitcnt vmcnt(19)
v_add_u32 v30, 1, v30
ds_write_b32 v31, v30
buffer_load_dwordx4 v19, s[20:23], s40 offen offset:3072 nt lds
s_add_u32 m0, m0, 4096
s_sub_u32 s44, s42, 10
s_waitcnt vmcnt(20)
buffer_load_dwordx4 v20, s[20:23], s41 offen offset:0 nt lds
s_waitcnt lgkmcnt(0)
v_readfirstlane_b32 s94, v32
v_readfirstlane_b32 s95, v33
s_waitcnt vmcnt(19)
buffer_load_dwordx4 v21, s[20:23], s41 offen offset:1024 nt lds
s_min_i32 s48, s95, s94
s_cmp_gt_i32 s48, s44
s_cselect_b32 s48, s62, s42
s_waitcnt vmcnt(20)
buffer_load_dwordx4 v22, s[20:23], s41 offen offset:2048 nt lds
v_cndmask_b32 v16, v4, v8, s[72:73]
v_cndmask_b32 v17, v5, v9, s[72:73]
v_cndmask_b32 v18, v6, v10, s[72:73]
v_cndmask_b32 v19, v7, v11, s[72:73]
s_waitcnt vmcnt(19)
buffer_load_dwordx4 v23, s[20:23], s41 offen offset:3072 nt lds
s_cmp_ge_u32 s42, s50
s_cselect_b32 s20, s8, s6
s_cselect_b32 s21, s9, s7
s_mov_b32 s40, s56
s_mov_b32 s41, s57
s_mov_b32 m0, s54
s_cmp_lg_u32 s48, s42
s_waitcnt vmcnt(20)
s_cbranch_scc1 L_first82
s_branch L_top82
L_N83:
s_add_i32 s43, s42, -3
v_mov_b32 v30, s43
s_branch L_go83
L_top83:
L_chk83:
s_waitcnt lgkmcnt(0)
v_readfirstlane_b32 s94, v32
v_readfirstlane_b32 s95, v33
s_min_i32 s48, s95, s94
s_cmp_gt_i32 s48, s44
s_cbranch_scc1 L_ok83
ds_read2_b32 v[32:33], v31 offset0:64 offset1:128
s_branch L_chk83
L_ok83:
s_cmp_eq_u32 s42, s62
s_cbranch_scc1 L_evt
L_go83:
s_mov_b32 m0, s54
s_nop 0
L_first83:
buffer_load_dwordx4 v16, s[20:23], s40 offen offset:0 nt lds
v_cndmask_b32 v20, v4, v12, s[72:73]
v_cndmask_b32 v21, v5, v13, s[72:73]
v_cndmask_b32 v22, v6, v14, s[72:73]
v_cndmask_b32 v23, v7, v15, s[72:73]
s_add_u32 s54, s54, 8192
s_cmp_eq_u32 s54, 81920
s_cselect_b32 s54, 0, s54
s_waitcnt vmcnt(19)
buffer_load_dwordx4 v17, s[20:23], s40 offen offset:1024 nt lds
s_add_u32 s42, s42, 1
s_add_u32 s53, s53, 1
s_cmp_eq_u32 s42, s50
s_cselect_b32 s53, 0, s53
ds_read2_b32 v[32:33], v31 offset0:64 offset1:128
s_waitcnt vmcnt(20)
buffer_load_dwordx4 v18, s[20:23], s40 offen offset:2048 nt lds
v_readlane_b32 s56, v24, s53
v_readlane_b32 s57, v25, s53
s_cmp_eq_u32 s53, s49
s_cselect_b64 s[72:73], -1, 0
s_waitcnt vmcnt(20)
buffer_load_dwordx4 v19, s[20:23], s40 offen offset:3072 nt lds
s_add_u32 m0, m0, 4096
s_sub_u32 s44, s42, 10
s_waitcnt vmcnt(20)
v_add_u32 v30, 1, v30
ds_write_b32 v31, v30
buffer_load_dwordx4 v20, s[20:23], s41 offen offset:0 nt lds
s_waitcnt lgkmcnt(0)
v_readfirstlane_b32 s94, v32
v_readfirstlane_b32 s95, v33
s_waitcnt vmcnt(19)
buffer_load_dwordx4 v21, s[20:23], s41 offen offset:1024 nt lds
s_min_i32 s48, s95, s94
s_cmp_gt_i32 s48, s44
s_cselect_b32 s48, s62, s42
s_waitcnt vmcnt(20)
buffer_load_dwordx4 v22, s[20:23], s41 offen offset:2048 nt lds
v_cndmask_b32 v16, v4, v8, s[72:73]
v_cndmask_b32 v17, v5, v9, s[72:73]
v_cndmask_b32 v18, v6, v10, s[72:73]
v_cndmask_b32 v19, v7, v11, s[72:73]
s_waitcnt vmcnt(20)
buffer_load_dwordx4 v23, s[20:23], s41 offen offset:3072 nt lds
s_cmp_ge_u32 s42, s50
s_cselect_b32 s20, s8, s6
s_cselect_b32 s21, s9, s7
s_mov_b32 s40, s56
s_mov_b32 s41, s57
s_mov_b32 m0, s54
s_cmp_lg_u32 s48, s42
s_waitcnt vmcnt(20)
s_cbranch_scc1 L_first83
s_branch L_top83
L_N84:
s_add_i32 s43, s42, -3
v_mov_b32 v30, s43
s_branch L_go84
L_top84:
L_chk84:
s_waitcnt lgkmcnt(0)
v_readfirstlane_b32 s94, v32
v_readfirstlane_b32 s95, v33
s_min_i32 s48, s95, s94
s_cmp_gt_i32 s48, s44
s_cbranch_scc1 L_ok84
ds_read2_b32 v[32:33], v31 offset0:64 offset1:128
s_branch L_chk84
L_ok84:
s_cmp_eq_u32 s42, s62
s_cbranch_scc1 L_evt
L_go84:
s_mov_b32 m0, s54
s_nop 0
L_first84:
buffer_load_dwordx4 v16, s[20:23], s40 offen offset:0 nt lds
v_cndmask_b32 v20, v4, v12, s[72:73]
v_cndmask_b32 v21, v5, v13, s[72:73]
v_cndmask_b32 v22, v6, v14, s[72:73]
v_cndmask_b32 v23, v7, v15, s[72:73]
s_add_u32 s54, s54, 8192
s_cmp_eq_u32 s54, 81920
s_cselect_b32 s54, 0, s54
s_waitcnt vmcnt(20)
buffer_load_dwordx4 v17, s[20:23], s40 offen offset:1024 nt lds
s_add_u32 s42, s42, 1
s_add_u32 s53, s53, 1
s_cmp_eq_u32 s42, s50
s_cselect_b32 s53, 0, s53
ds_read2_b32 v[32:33], v31 offset0:64 offset1:128
s_waitcnt vmcnt(20)
buffer_load_dwordx4 v18, s[20:23], s40 offen offset:2048 nt lds
v_readlane_b32 s56, v24, s53
v_readlane_b32 s57, v25, s53
s_cmp_eq_u32 s53, s49
s_cselect_b64 s[72:73], -1, 0
s_waitcnt vmcnt(20)
buffer_load_dwordx4 v19, s[20:23], s40 offen offset:3072 nt lds
s_add_u32 m0, m0, 4096
s_sub_u32 s44, s42, 10
s_waitcnt vmcnt(20)
v_add_u32 v30, 1, v30
ds_write_b32 v31, v30
buffer_load_dwordx4 v20, s[20:23], s41 offen offset:0 nt lds
s_waitcnt lgkmcnt(0)
v_readfirstlane_b32 s94, v32
v_readfirstlane_b32 s95, v33
s_waitcnt vmcnt(20)
buffer_load_dwordx4 v21, s[20:23], s41 offen offset:1024 nt lds
s_min_i32 s48, s95, s94
s_cmp_gt_i32 s48, s44
s_cselect_b32 s48, s62, s42
s_waitcnt vmcnt(20)
buffer_load_dwordx4 v22, s[20:23], s41 offen offset:2048 nt lds
v_cndmask_b32 v16, v4, v8, s[72:73]
v_cndmask_b32 v17, v5, v9, s[72:73]
v_cndmask_b32 v18, v6, v10, s[72:73]
v_cndmask_b32 v19, v7, v11, s[72:73]
s_waitcnt vmcnt(20)
buffer_load_dwordx4 v23, s[20:23], s41 offen offset:3072 nt lds
s_cmp_ge_u32 s42, s50
s_cselect_b32 s20, s8, s6
s_cselect_b32 s21, s9, s7
s_mov_b32 s40, s56
s_mov_b32 s41, s57
s_mov_b32 m0, s54
s_cmp_lg_u32 s48, s42
s_waitcnt vmcnt(20)
s_cbranch_scc1 L_first84
s_branch L_top84
L_N85:
s_add_i32 s43, s42, -3
v_mov_b32 v30, s43
s_branch L_go85
L_top85:
L_chk85:
s_waitcnt lgkmcnt(0)
v_readfirstlane_b32 s94, v32
v_readfirstlane_b32 s95, v33
s_min_i32 s48, s95, s94
s_cmp_gt_i32 s48, s44
s_cbranch_scc1 L_ok85
ds_read2_b32 v[32:33], v31 offset0:64 offset1:128
s_branch L_chk85
L_ok85:
s_cmp_eq_u32 s42, s62
s_cbranch_scc1 L_evt
L_go85:
s_mov_b32 m0, s54
s_nop 0
L_first85:
buffer_load_dwordx4 v16, s[20:23], s40 offen offset:0 nt lds
v_cndmask_b32 v20, v4, v12, s[72:73]
v_cndmask_b32 v21, v5, v13, s[72:73]
v_cndmask_b32 v22, v6, v14, s[72:73]
v_cndmask_b32 v23, v7, v15, s[72:73]
s_add_u32 s54, s54, 8192
s_cmp_eq_u32 s54, 81920
s_cselect_b32 s54, 0, s54
s_waitcnt vmcnt(20)
buffer_load_dwordx4 v17, s[20:23], s40 offen offset:1024 nt lds
s_add_u32 s42, s42, 1
s_add_u32 s53, s53, 1
s_cmp_eq_u32 s42, s50
s_cselect_b32 s53, 0, s53
ds_read2_b32 v[32:33], v31 offset0:64 offset1:128
s_waitcnt vmcnt(20)
buffer_load_dwordx4 v18, s[20:23], s40 offen offset:2048 nt lds
v_readlane_b32 s56, v24, s53
v_readlane_b32 s57, v25, s53
s_cmp_eq_u32 s53, s49
s_cselect_b64 s[72:73], -1, 0
s_waitcnt vmcnt(20)
buffer_load_dwordx4 v19, s[20:23], s40 offen offset:3072 nt lds
s_add_u32 m0, m0, 4096
s_sub_u32 s44, s42, 10
s_waitcnt vmcnt(21)
buffer_load_dwordx4 v20, s[20:23], s41 offen offset:0 nt lds
s_waitcnt lgkmcnt(0)
v_readfirstlane_b32 s94, v32
v_readfirstlane_b32 s95, v33
s_waitcnt vmcnt(20)
v_add_u32 v30, 1, v30
ds_write_b32 v31, v30
buffer_load_dwordx4 v21, s[20:23], s41 offen offset:1024 nt lds
s_min_i32 s48, s95, s94
s_cmp_gt_i32 s48, s44
s_cselect_b32 s48, s62, s42
s_waitcnt vmcnt(20)
buffer_load_dwordx4 v22, s[20:23], s41 offen offset:2048 nt lds
v_cndmask_b32 v16, v4, v8, s[72:73]
v_cndmask_b32 v17, v5, v9, s[72:73]
v_cndmask_b32 v18, v6, v10, s[72:73]
v_cndmask_b32 v19, v7, v11, s[72:73]
s_waitcnt vmcnt(20)
buffer_load_dwordx4 v23, s[20:23], s41 offen offset:3072 nt lds
s_cmp_ge_u32 s42, s50
s_cselect_b32 s20, s8, s6
s_cselect_b32 s21, s9, s7
s_mov_b32 s40, s56
s_mov_b32 s41, s57
s_mov_b32 m0, s54
s_cmp_lg_u32 s48, s42
s_waitcnt vmcnt(21)
s_cbranch_scc1 L_first85
s_branch L_top85
L_N86:
s_add_i32 s43, s42, -3
v_mov_b32 v30, s43
s_branch L_go86
L_top86:
L_chk86:
s_waitcnt lgkmcnt(0)
v_readfirstlane_b32 s94, v32
v_readfirstlane_b32 s95, v33
s_min_i32 s48, s95, s94
s_cmp_gt_i32 s48, s44
s_cbranch_scc1 L_ok86
ds_read2_b32 v[32:33], v31 offset0:64 offset1:128
s_branch L_chk86
L_ok86:
s_cmp_eq_u32 s42, s62
s_cbranch_scc1 L_evt
L_go86:
s_mov_b32 m0, s54
s_nop 0
L_first86:
buffer_load_dwordx4 v16, s[20:23], s40 offen offset:0 nt lds
v_cndmask_b32 v20, v4, v12, s[72:73]
v_cndmask_b32 v21, v5, v13, s[72:73]
v_cndmask_b32 v22, v6, v14, s[72:73]
v_cndmask_b32 v23, v7, v15, s[72:73]
s_add_u32 s54, s54, 8192
s_cmp_eq_u32 s54, 81920
s_cselect_b32 s54, 0, s54
s_waitcnt vmcnt(20)
buffer_load_dwordx4 v17, s[20:23], s40 offen offset:1024 nt lds
s_add_u32 s42, s42, 1
s_add_u32 s53, s53, 1
s_cmp_eq_u32 s42, s50
s_cselect_b32 s53, 0, s53
ds_read2_b32 v[32:33], v31 offset0:64 offset1:128
s_waitcnt vmcnt(21)
buffer_load_dwordx4 v18, s[20:23], s40 offen offset:2048 nt lds
v_readlane_b32 s56, v24, s53
v_readlane_b32 s57, v25, s53
s_cmp_eq_u32 s53, s49
s_cselect_b64 s[72:73], -1, 0
s_waitcnt vmcnt(20)
buffer_load_dwordx4 v19, s[20:23], s40 offen offset:3072 nt lds
s_add_u32 m0, m0, 4096
s_sub_u32 s44, s42, 10
s_waitcnt vmcnt(21)
buffer_load_dwordx4 v20, s[20:23], s41 offen offset:0 nt lds
s_waitcnt lgkmcnt(0)
v_readfirstlane_b32 s94, v32
v_readfirstlane_b32 s95, v33
s_waitcnt vmcnt(20)
v_add_u32 v30, 1, v30
ds_write_b32 v31, v30
buffer_load_dwordx4 v21, s[20:23], s41 offen offset:1024 nt lds
s_min_i32 s48, s95, s94
s_cmp_gt_i32 s48, s44
s_cselect_b32 s48, s62, s42
s_waitcnt vmcnt(21)
buffer_load_dwordx4 v22, s[20:23], s41 offen offset:2048 nt lds
v_cndmask_b32 v16, v4, v8, s[72:73]
v_cndmask_b32 v17, v5, v9, s[72:73]
v_cndmask_b32 v18, v6, v10, s[72:73]
v_cndmask_b32 v19, v7, v11, s[72:73]
s_waitcnt vmcnt(20)
buffer_load_dwordx4 v23, s[20:23], s41 offen offset:3072 nt lds
s_cmp_ge_u32 s42, s50
s_cselect_b32 s20, s8, s6
s_cselect_b32 s21, s9, s7
s_mov_b32 s40, s56
s_mov_b32 s41, s57
s_mov_b32 m0, s54
s_cmp_lg_u32 s48, s42
s_waitcnt vmcnt(21)
s_cbranch_scc1 L_first86
s_branch L_top86
L_N87:
s_add_i32 s43, s42, -3
v_mov_b32 v30, s43
s_branch L_go87
L_top87:
L_chk87:
s_waitcnt lgkmcnt(0)
v_readfirstlane_b32 s94, v32
v_readfirstlane_b32 s95, v33
s_min_i32 s48, s95, s94
s_cmp_gt_i32 s48, s44
s_cbranch_scc1 L_ok87
ds_read2_b32 v[32:33], v31 offset0:64 offset1:128
s_branch L_chk87
L_ok87:
s_cmp_eq_u32 s42, s62
s_cbranch_scc1 L_evt
L_go87:
s_mov_b32 m0, s54
s_nop 0
L_first87:
buffer_load_dwordx4 v16, s[20:23], s40 offen offset:0 nt lds
v_cndmask_b32 v20, v4, v12, s[72:73]
v_cndmask_b32 v21, v5, v13, s[72:73]
v_cndmask_b32 v22, v6, v14, s[72:73]
v_cndmask_b32 v23, v7, v15, s[72:73]
s_add_u32 s54, s54, 8192
s_cmp_eq_u32 s54, 81920
s_cselect_b32 s54, 0, s54
s_waitcnt vmcnt(20)
buffer_load_dwordx4 v17, s[20:23], s40 offen offset:1024 nt lds
s_add_u32 s42, s42, 1
s_add_u32 s53, s53, 1
s_cmp_eq_u32 s42, s50
s_cselect_b32 s53, 0, s53
ds_read2_b32 v[32:33], v31 offset0:64 offset1:128
s_waitcnt vmcnt(21)
buffer_load_dwordx4 v18, s[20:23], s40 offen offset:2048 nt lds
v_readlane_b32 s56, v24, s53
v_readlane_b32 s57, v25, s53
s_cmp_eq_u32 s53, s49
s_cselect_b64 s[72:73], -1, 0
s_waitcnt vmcnt(21)
buffer_load_dwordx4 v19, s[20:23], s40 offen offset:3072 nt lds
s_add_u32 m0, m0, 4096
s_sub_u32 s44, s42, 10
s_waitcnt vmcnt(21)
buffer_load_dwordx4 v20, s[20:23], s41 offen offset:0 nt lds
s_waitcnt lgkmcnt(0)
v_readfirstlane_b32 s94, v32
v_readfirstlane_b32 s95, v33
s_waitcnt vmcnt(20)
v_add_u32 v30, 1, v30
ds_write_b32 v31, v30
buffer_load_dwordx4 v21, s[20:23], s41 offen offset:1024 nt lds
s_min_i32 s48, s95, s94
s_cmp_gt_i32 s48, s44
s_cselect_b32 s48, s62, s42
s_waitcnt vmcnt(21)
buffer_load_dwordx4 v22, s[20:23], s41 offen offset:2048 nt lds
v_cndmask_b32 v16, v4, v8, s[72:73]
v_cndmask_b32 v17, v5, v9, s[72:73]
v_cndmask_b32 v18, v6, v10, s[72:73]
v_cndmask_b32 v19, v7, v11, s[72:73]
s_waitcnt vmcnt(21)
buffer_load_dwordx4 v23, s[20:23], s41 offen offset:3072 nt lds
s_cmp_ge_u32 s42, s50
s_cselect_b32 s20, s8, s6
s_cselect_b32 s21, s9, s7
s_mov_b32 s40, s56
s_mov_b32 s41, s57
s_mov_b32 m0, s54
s_cmp_lg_u32 s48, s42
s_waitcnt vmcnt(21)
s_cbranch_scc1 L_first87
s_branch L_top87
L_N88:
s_add_i32 s43, s42, -3
v_mov_b32 v30, s43
s_branch L_go88
L_top88:
L_chk88:
s_waitcnt lgkmcnt(0)
v_readfirstlane_b32 s94, v32
v_readfirstlane_b32 s95, v33
s_min_i32 s48, s95, s94
s_cmp_gt_i32 s48, s44
s_cbranch_scc1 L_ok88
ds_read2_b32 v[32:33], v31 offset0:64 offset1:128
s_branch L_chk88
L_ok88:
s_cmp_eq_u32 s42, s62
s_cbranch_scc1 L_evt
L_go88:
s_mov_b32 m0, s54
s_nop 0
L_first88:
buffer_load_dwordx4 v16, s[20:23], s40 offen offset:0 nt lds
v_cndmask_b32 v20, v4, v12, s[72:73]
v_cndmask_b32 v21, v5, v13, s[72:73]
v_cndmask_b32 v22, v6, v14, s[72:73]
v_cndmask_b32 v23, v7, v15, s[72:73]
s_add_u32 s54, s54, 8192
s_cmp_eq_u32 s54, 81920
s_cselect_b32 s54, 0, s54
s_waitcnt vmcnt(21)
buffer_load_dwordx4 v17, s[20:23], s40 offen offset:1024 nt lds
s_add_u32 s42, s42, 1
s_add_u32 s53, s53, 1
s_cmp_eq_u32 s42, s50
s_cselect_b32 s53, 0, s53
ds_read2_b32 v[32:33], v31 offset0:64 offset1:128
s_waitcnt vmcnt(21)
buffer_load_dwordx4 v18, s[20:23], s40 offen offset:2048 nt lds
v_readlane_b32 s56, v24, s53
v_readlane_b32 s57, v25, s53
s_cmp_eq_u32 s53, s49
s_cselect_b64 s[72:73], -1, 0
s_waitcnt vmcnt(21)
buffer_load_dwordx4 v19, s[20:23], s40 offen offset:3072 nt lds
s_add_u32 m0, m0, 4096
s_sub_u32 s44, s42, 10
s_waitcnt vmcnt(21)
buffer_load_dwordx4 v20, s[20:23], s41 offen offset:0 nt lds
s_waitcnt lgkmcnt(0)
v_readfirstlane_b32 s94, v32
v_readfirstlane_b32 s95, v33
s_waitcnt vmcnt(21)
v_add_u32 v30, 1, v30
ds_write_b32 v31, v30
buffer_load_dwordx4 v21, s[20:23], s41 offen offset:1024 nt lds
s_min_i32 s48, s95, s94
s_cmp_gt_i32 s48, s44
s_cselect_b32 s48, s62, s42
s_waitcnt vmcnt(21)
buffer_load_dwordx4 v22, s[20:23], s41 offen offset:2048 nt lds
v_cndmask_b32 v16, v4, v8, s[72:73]
v_cndmask_b32 v17, v5, v9, s[72:73]
v_cndmask_b32 v18, v6, v10, s[72:73]
v_cndmask_b32 v19, v7, v11, s[72:73]
s_waitcnt vmcnt(21)
buffer_load_dwordx4 v23, s[20:23], s41 offen offset:3072 nt lds
s_cmp_ge_u32 s42, s50
s_cselect_b32 s20, s8, s6
s_cselect_b32 s21, s9, s7
s_mov_b32 s40, s56
s_mov_b32 s41, s57
s_mov_b32 m0, s54
s_cmp_lg_u32 s48, s42
s_waitcnt vmcnt(21)
s_cbranch_scc1 L_first88
s_branch L_top88
L_N89:
s_add_i32 s43, s42, -3
v_mov_b32 v30, s43
s_branch L_go89
L_top89:
L_chk89:
s_waitcnt lgkmcnt(0)
v_readfirstlane_b32 s94, v32
v_readfirstlane_b32 s95, v33
s_min_i32 s48, s95, s94
s_cmp_gt_i32 s48, s44
s_cbranch_scc1 L_ok89
ds_read2_b32 v[32:33], v31 offset0:64 offset1:128
s_branch L_chk89
L_ok89:
s_cmp_eq_u32 s42, s62
s_cbranch_scc1 L_evt
L_go89:
s_mov_b32 m0, s54
s_nop 0
L_first89:
buffer_load_dwordx4 v16, s[20:23], s40 offen offset:0 nt lds
v_cndmask_b32 v20, v4, v12, s[72:73]
v_cndmask_b32 v21, v5, v13, s[72:73]
v_cndmask_b32 v22, v6, v14, s[72:73]
v_cndmask_b32 v23, v7, v15, s[72:73]
s_add_u32 s54, s54, 8192
s_cmp_eq_u32 s54, 81920
s_cselect_b32 s54, 0, s54
s_waitcnt vmcnt(21)
buffer_load_dwordx4 v17, s[20:23], s40 offen offset:1024 nt lds
s_add_u32 s42, s42, 1
s_add_u32 s53, s53, 1
s_cmp_eq_u32 s42, s50
s_cselect_b32 s53, 0, s53
ds_read2_b32 v[32:33], v31 offset0:64 offset1:128
s_waitcnt vmcnt(21)
buffer_load_dwordx4 v18, s[20:23], s40 offen offset:2048 nt lds
v_readlane_b32 s56, v24, s53
v_readlane_b32 s57, v25, s53
s_cmp_eq_u32 s53, s49
s_cselect_b64 s[72:73], -1, 0
s_waitcnt vmcnt(21)
buffer_load_dwordx4 v19, s[20:23], s40 offen offset:3072 nt lds
s_add_u32 m0, m0, 4096
s_sub_u32 s44, s42, 10
s_waitcnt vmcnt(22)
buffer_load_dwordx4 v20, s[20:23], s41 offen offset:0 nt lds
s_waitcnt lgkmcnt(0)
v_readfirstlane_b32 s94, v32
v_readfirstlane_b32 s95, v33
s_waitcnt vmcnt(21)
v_add_u32 v30, 1, v30
ds_write_b32 v31, v30
buffer_load_dwordx4 v21, s[20:23], s41 offen offset:1024 nt lds
s_min_i32 s48, s95, s94
s_cmp_gt_i32 s48, s44
s_cselect_b32 s48, s62, s42
s_waitcnt vmcnt(21)
buffer_load_dwordx4 v22, s[20:23], s41 offen offset:2048 nt lds
v_cndmask_b32 v16, v4, v8, s[72:73]
v_cndmask_b32 v17, v5, v9, s[72:73]
v_cndmask_b32 v18, v6, v10, s[72:73]
v_cndmask_b32 v19, v7, v11, s[72:73]
s_waitcnt vmcnt(21)
buffer_load_dwordx4 v23, s[20:23], s41 offen offset:3072 nt lds
s_cmp_ge_u32 s42, s50
s_cselect_b32 s20, s8, s6
s_cselect_b32 s21, s9, s7
s_mov_b32 s40, s56
s_mov_b32 s41, s57
s_mov_b32 m0, s54
s_cmp_lg_u32 s48, s42
s_waitcnt vmcnt(22)
s_cbranch_scc1 L_first89
s_branch L_top89
L_N90:
s_add_i32 s43, s42, -3
v_mov_b32 v30, s43
s_branch L_go90
L_top90:
L_chk90:
s_waitcnt lgkmcnt(0)
v_readfirstlane_b32 s94, v32
v_readfirstlane_b32 s95, v33
s_min_i32 s48, s95, s94
s_cmp_gt_i32 s48, s44
s_cbranch_scc1 L_ok90
ds_read2_b32 v[32:33], v31 offset0:64 offset1:128
s_branch L_chk90
L_ok90:
s_cmp_eq_u32 s42, s62
s_cbranch_scc1 L_evt
L_go90:
s_mov_b32 m0, s54
s_nop 0
L_first90:
buffer_load_dwordx4 v16, s[20:23], s40 offen offset:0 nt lds
v_cndmask_b32 v20, v4, v12, s[72:73]
v_cndmask_b32 v21, v5, v13, s[72:73]
v_cndmask_b32 v22, v6, v14, s[72:73]
v_cndmask_b32 v23, v7, v15, s[72:73]
s_add_u32 s54, s54, 8192
s_cmp_eq_u32 s54, 81920
s_cselect_b32 s54, 0, s54
s_waitcnt vmcnt(21)
buffer_load_dwordx4 v17, s[20:23], s40 offen offset:1024 nt lds
s_add_u32 s42, s42, 1
s_add_u32 s53, s53, 1
s_cmp_eq_u32 s42, s50
s_cselect_b32 s53, 0, s53
ds_read2_b32 v[32:33], v31 offset0:64 offset1:128
s_waitcnt vmcnt(22)
buffer_load_dwordx4 v18, s[20:23], s40 offen offset:2048 nt lds
v_readlane_b32 s56, v24, s53
v_readlane_b32 s57, v25, s53
s_cmp_eq_u32 s53, s49
s_cselect_b64 s[72:73], -1, 0
s_waitcnt vmcnt(21)
buffer_load_dwordx4 v19, s[20:23], s40 offen offset:3072 nt lds
s_add_u32 m0, m0, 4096
s_sub_u32 s44, s42, 10
s_waitcnt vmcnt(22)
buffer_load_dwordx4 v20, s[20:23], s41 offen offset:0 nt lds
s_waitcnt lgkmcnt(0)
v_readfirstlane_b32 s94, v32
v_readfirstlane_b32 s95, v33
s_waitcnt vmcnt(21)
v_add_u32 v30, 1, v30
ds_write_b32 v31, v30
buffer_load_dwordx4 v21, s[20:23], s41 offen offset:1024 nt lds
s_min_i32 s48, s95, s94
s_cmp_gt_i32 s48, s44
s_cselect_b32 s48, s62, s42
s_waitcnt vmcnt(22)
buffer_load_dwordx4 v22, s[20:23], s41 offen offset:2048 nt lds
v_cndmask_b32 v16, v4, v8, s[72:73]
v_cndmask_b32 v17, v5, v9, s[72:73]
v_cndmask_b32 v18, v6, v10, s[72:73]
v_cndmask_b32 v19, v7, v11, s[72:73]
s_waitcnt vmcnt(21)
buffer_load_dwordx4 v23, s[20:23], s41 offen offset:3072 nt lds
s_cmp_ge_u32 s42, s50
s_cselect_b32 s20, s8, s6
s_cselect_b32 s21, s9, s7
s_mov_b32 s40, s56
s_mov_b32 s41, s57
s_mov_b32 m0, s54
s_cmp_lg_u32 s48, s42
s_waitcnt vmcnt(22)
s_cbranch_scc1 L_first90
s_branch L_top90
L_N91:
s_add_i32 s43, s42, -3
v_mov_b32 v30, s43
s_branch L_go91
L_top91:
L_chk91:
s_waitcnt lgkmcnt(0)
v_readfirstlane_b32 s94, v32
v_readfirstlane_b32 s95, v33
s_min_i32 s48, s95, s94
s_cmp_gt_i32 s48, s44
s_cbranch_scc1 L_ok91
ds_read2_b32 v[32:33], v31 offset0:64 offset1:128
s_branch L_chk91
L_ok91:
s_cmp_eq_u32 s42, s62
s_cbranch_scc1 L_evt
L_go91:
s_mov_b32 m0, s54
s_nop 0
L_first91:
buffer_load_dwordx4 v16, s[20:23], s40 offen offset:0 nt lds
v_cndmask_b32 v20, v4, v12, s[72:73]
v_cndmask_b32 v21, v5, v13, s[72:73]
v_cndmask_b32 v22, v6, v14, s[72:73]
v_cndmask_b32 v23, v7, v15, s[72:73]
s_add_u32 s54, s54, 8192
s_cmp_eq_u32 s54, 81920
s_cselect_b32 s54, 0, s54
s_waitcnt vmcnt(21)
buffer_load_dwordx4 v17, s[20:23], s40 offen offset:1024 nt lds
s_add_u32 s42, s42, 1
s_add_u32 s53, s53, 1
s_cmp_eq_u32 s42, s50
s_cselect_b32 s53, 0, s53
ds_read2_b32 v[32:33], v31 offset0:64 offset1:128
s_waitcnt vmcnt(22)
buffer_load_dwordx4 v18, s[20:23], s40 offen offset:2048 nt lds
v_readlane_b32 s56, v24, s53
v_readlane_b32 s57, v25, s53
s_cmp_eq_u32 s53, s49
s_cselect_b64 s[72:73], -1, 0
s_waitcnt vmcnt(22)
buffer_load_dwordx4 v19, s[20:23], s40 offen offset:3072 nt lds
s_add_u32 m0, m0, 4096
s_sub_u32 s44, s42, 10
s_waitcnt vmcnt(22)
buffer_load_dwordx4 v20, s[20:23], s41 offen offset:0 nt lds
s_waitcnt lgkmcnt(0)
v_readfirstlane_b32 s94, v32
v_readfirstlane_b32 s95, v33
s_waitcnt vmcnt(21)
v_add_u32 v30, 1, v30
ds_write_b32 v31, v30
buffer_load_dwordx4 v21, s[20:23], s41 offen offset:1024 nt lds
s_min_i32 s48, s95, s94
s_cmp_gt_i32 s48, s44
s_cselect_b32 s48, s62, s42
s_waitcnt vmcnt(22)
buffer_load_dwordx4 v22, s[20:23], s41 offen offset:2048 nt lds
v_cndmask_b32 v16, v4, v8, s[72:73]
v_cndmask_b32 v17, v5, v9, s[72:73]
v_cndmask_b32 v18, v6, v10, s[72:73]
v_cndmask_b32 v19, v7, v11, s[72:73]
s_waitcnt vmcnt(22)
buffer_load_dwordx4 v23, s[20:23], s41 offen offset:3072 nt lds
s_cmp_ge_u32 s42, s50
s_cselect_b32 s20, s8, s6
s_cselect_b32 s21, s9, s7
s_mov_b32 s40, s56
s_mov_b32 s41, s57
s_mov_b32 m0, s54
s_cmp_lg_u32 s48, s42
s_waitcnt vmcnt(22)
s_cbranch_scc1 L_first91
s_branch L_top91
L_N92:
s_add_i32 s43, s42, -3
v_mov_b32 v30, s43
s_branch L_go92
L_top92:
L_chk92:
s_waitcnt lgkmcnt(0)
v_readfirstlane_b32 s94, v32
v_readfirstlane_b32 s95, v33
s_min_i32 s48, s95, s94
s_cmp_gt_i32 s48, s44
s_cbranch_scc1 L_ok92
ds_read2_b32 v[32:33], v31 offset0:64 offset1:128
s_branch L_chk92
L_ok92:
s_cmp_eq_u32 s42, s62
s_cbranch_scc1 L_evt
L_go92:
s_mov_b32 m0, s54
s_nop 0
L_first92:
buffer_load_dwordx4 v16, s[20:23], s40 offen offset:0 nt lds
v_cndmask_b32 v20, v4, v12, s[72:73]
v_cndmask_b32 v21, v5, v13, s[72:73]
v_cndmask_b32 v22, v6, v14, s[72:73]
v_cndmask_b32 v23, v7, v15, s[72:73]
s_add_u32 s54, s54, 8192
s_cmp_eq_u32 s54, 81920
s_cselect_b32 s54, 0, s54
s_waitcnt vmcnt(22)
buffer_load_dwordx4 v17, s[20:23], s40 offen offset:1024 nt lds
s_add_u32 s42, s42, 1
s_add_u32 s53, s53, 1
s_cmp_eq_u32 s42, s50
s_cselect_b32 s53, 0, s53
ds_read2_b32 v[32:33], v31 offset0:64 offset1:128
s_waitcnt vmcnt(22)
buffer_load_dwordx4 v18, s[20:23], s40 offen offset:2048 nt lds
v_readlane_b32 s56, v24, s53
v_readlane_b32 s57, v25, s53
s_cmp_eq_u32 s53, s49
s_cselect_b64 s[72:73], -1, 0
s_waitcnt vmcnt(22)
buffer_load_dwordx4 v19, s[20:23], s40 offen offset:3072 nt lds
s_add_u32 m0, m0, 4096
s_sub_u32 s44, s42, 10
s_waitcnt vmcnt(22)
buffer_load_dwordx4 v20, s[20:23], s41 offen offset:0 nt lds
s_waitcnt lgkmcnt(0)
v_readfirstlane_b32 s94, v32
v_readfirstlane_b32 s95, v33
s_waitcnt vmcnt(22)
buffer_load_dwordx4 v21, s[20:23], s41 offen offset:1024 nt lds
s_min_i32 s48, s95, s94
s_cmp_gt_i32 s48, s44
s_cselect_b32 s48, s62, s42
s_waitcnt vmcnt(22)
v_add_u32 v30, 1, v30
ds_write_b32 v31, v30
buffer_load_dwordx4 v22, s[20:23], s41 offen offset:2048 nt lds
v_cndmask_b32 v16, v4, v8, s[72:73]
v_cndmask_b32 v17, v5, v9, s[72:73]
v_cndmask_b32 v18, v6, v10, s[72:73]
v_cndmask_b32 v19, v7, v11, s[72:73]
s_waitcnt vmcnt(22)
buffer_load_dwordx4 v23, s[20:23], s41 offen offset:3072 nt lds
s_cmp_ge_u32 s42, s50
s_cselect_b32 s20, s8, s6
s_cselect_b32 s21, s9, s7
s_mov_b32 s40, s56
s_mov_b32 s41, s57
s_mov_b32 m0, s54
s_cmp_lg_u32 s48, s42
s_waitcnt vmcnt(22)
s_cbranch_scc1 L_first92
s_branch L_top92
L_N93:
s_add_i32 s43, s42, -3
v_mov_b32 v30, s43
s_branch L_go93
L_top93:
L_chk93:
s_waitcnt lgkmcnt(0)
v_readfirstlane_b32 s94, v32
v_readfirstlane_b32 s95, v33
s_min_i32 s48, s95, s94
s_cmp_gt_i32 s48, s44
s_cbranch_scc1 L_ok93
ds_read2_b32 v[32:33], v31 offset0:64 offset1:128
s_branch L_chk93
L_ok93:
s_cmp_eq_u32 s42, s62
s_cbranch_scc1 L_evt
L_go93:
s_mov_b32 m0, s54
s_nop 0
L_first93:
buffer_load_dwordx4 v16, s[20:23], s40 offen offset:0 nt lds
v_cndmask_b32 v20, v4, v12, s[72:73]
v_cndmask_b32 v21, v5, v13, s[72:73]
v_cndmask_b32 v22, v6, v14, s[72:73]
v_cndmask_b32 v23, v7, v15, s[72:73]
s_add_u32 s54, s54, 8192
s_cmp_eq_u32 s54, 81920
s_cselect_b32 s54, 0, s54
s_waitcnt vmcnt(22)
buffer_load_dwordx4 v17, s[20:23], s40 offen offset:1024 nt lds
s_add_u32 s42, s42, 1
s_add_u32 s53, s53, 1
s_cmp_eq_u32 s42, s50
s_cselect_b32 s53, 0, s53
ds_read2_b32 v[32:33], v31 offset0:64 offset1:128
s_waitcnt vmcnt(22)
buffer_load_dwordx4 v18, s[20:23], s40 offen offset:2048 nt lds
v_readlane_b32 s56, v24, s53
v_readlane_b32 s57, v25, s53
s_cmp_eq_u32 s53, s49
s_cselect_b64 s[72:73], -1, 0
s_waitcnt vmcnt(22)
buffer_load_dwordx4 v19, s[20:23], s40 offen offset:3072 nt lds
s_add_u32 m0, m0, 4096
s_sub_u32 s44, s42, 10
s_waitcnt vmcnt(23)
buffer_load_dwordx4 v20, s[20:23], s41 offen offset:0 nt lds
s_waitcnt lgkmcnt(0)
v_readfirstlane_b32 s94, v32
v_readfirstlane_b32 s95, v33
s_waitcnt vmcnt(22)
buffer_load_dwordx4 v21, s[20:23], s41 offen offset:1024 nt lds
s_min_i32 s48, s95, s94
s_cmp_gt_i32 s48, s44
s_cselect_b32 s48, s62, s42
s_waitcnt vmcnt(22)
v_add_u32 v30, 1, v30
ds_write_b32 v31, v30
buffer_load_dwordx4 v22, s[20:23], s41 offen offset:2048 nt lds
v_cndmask_b32 v16, v4, v8, s[72:73]
v_cndmask_b32 v17, v5, v9, s[72:73]
v_cndmask_b32 v18, v6, v10, s[72:73]
v_cndmask_b32 v19, v7, v11, s[72:73]
s_waitcnt vmcnt(22)
buffer_load_dwordx4 v23, s[20:23], s41 offen offset:3072 nt lds
s_cmp_ge_u32 s42, s50
s_cselect_b32 s20, s8, s6
s_cselect_b32 s21, s9, s7
s_mov_b32 s40, s56
s_mov_b32 s41, s57
s_mov_b32 m0, s54
s_cmp_lg_u32 s48, s42
s_waitcnt vmcnt(23)
s_cbranch_scc1 L_first93
s_branch L_top93
L_N94:
s_add_i32 s43, s42, -3
v_mov_b32 v30, s43
s_branch L_go94
L_top94:
L_chk94:
s_waitcnt lgkmcnt(0)
v_readfirstlane_b32 s94, v32
v_readfirstlane_b32 s95, v33
s_min_i32 s48, s95, s94
s_cmp_gt_i32 s48, s44
s_cbranch_scc1 L_ok94
ds_read2_b32 v[32:33], v31 offset0:64 offset1:128
s_branch L_chk94
L_ok94:
s_cmp_eq_u32 s42, s62
s_cbranch_scc1 L_evt
L_go94:
s_mov_b32 m0, s54
s_nop 0
L_first94:
buffer_load_dwordx4 v16, s[20:23], s40 offen offset:0 nt lds
v_cndmask_b32 v20, v4, v12, s[72:73]
v_cndmask_b32 v21, v5, v13, s[72:73]
v_cndmask_b32 v22, v6, v14, s[72:73]
v_cndmask_b32 v23, v7, v15, s[72:73]
s_add_u32 s54, s54, 8192
s_cmp_eq_u32 s54, 81920
s_cselect_b32 s54, 0, s54
s_waitcnt vmcnt(22)
buffer_load_dwordx4 v17, s[20:23], s40 offen offset:1024 nt lds
s_add_u32 s42, s42, 1
s_add_u32 s53, s53, 1
s_cmp_eq_u32 s42, s50
s_cselect_b32 s53, 0, s53
ds_read2_b32 v[32:33], v31 offset0:64 offset1:128
s_waitcnt vmcnt(23)
buffer_load_dwordx4 v18, s[20:23], s40 offen offset:2048 nt lds
v_readlane_b32 s56, v24, s53
v_readlane_b32 s57, v25, s53
s_cmp_eq_u32 s53, s49
s_cselect_b64 s[72:73], -1, 0
s_waitcnt vmcnt(22)
buffer_load_dwordx4 v19, s[20:23], s40 offen offset:3072 nt lds
s_add_u32 m0, m0, 4096
s_sub_u32 s44, s42, 10
s_waitcnt vmcnt(23)
buffer_load_dwordx4 v20, s[20:23], s41 offen offset:0 nt lds
s_waitcnt lgkmcnt(0)
v_readfirstlane_b32 s94, v32
v_readfirstlane_b32 s95, v33
s_waitcnt vmcnt(22)
buffer_load_dwordx4 v21, s[20:23], s41 offen offset:1024 nt lds
s_min_i32 s48, s95, s94
s_cmp_gt_i32 s48, s44
s_cselect_b32 s48, s62, s42
s_waitcnt vmcnt(23)
buffer_load_dwordx4 v22, s[20:23], s41 offen offset:2048 nt lds
v_cndmask_b32 v16, v4, v8, s[72:73]
v_cndmask_b32 v17, v5, v9, s[72:73]
v_cndmask_b32 v18, v6, v10, s[72:73]
v_cndmask_b32 v19, v7, v11, s[72:73]
s_waitcnt vmcnt(22)
v_add_u32 v30, 1, v30
ds_write_b32 v31, v30
buffer_load_dwordx4 v23, s[20:23], s41 offen offset:3072 nt lds
s_cmp_ge_u32 s42, s50
s_cselect_b32 s20, s8, s6
s_cselect_b32 s21, s9, s7
s_mov_b32 s40, s56
s_mov_b32 s41, s57
s_mov_b32 m0, s54
s_cmp_lg_u32 s48, s42
s_waitcnt vmcnt(23)
s_cbranch_scc1 L_first94
s_branch L_top94
L_N95:
s_add_i32 s43, s42, -3
v_mov_b32 v30, s43
s_branch L_go95
L_top95:
L_chk95:
s_waitcnt lgkmcnt(0)
v_readfirstlane_b32 s94, v32
v_readfirstlane_b32 s95, v33
s_min_i32 s48, s95, s94
s_cmp_gt_i32 s48, s44
s_cbranch_scc1 L_ok95
ds_read2_b32 v[32:33], v31 offset0:64 offset1:128
s_branch L_chk95
L_ok95:
s_cmp_eq_u32 s42, s62
s_cbranch_scc1 L_evt
L_go95:
s_mov_b32 m0, s54
s_nop 0
L_first95:
buffer_load_dwordx4 v16, s[20:23], s40 offen offset:0 nt lds
v_cndmask_b32 v20, v4, v12, s[72:73]
v_cndmask_b32 v21, v5, v13, s[72:73]
v_cndmask_b32 v22, v6, v14, s[72:73]
v_cndmask_b32 v23, v7, v15, s[72:73]
s_add_u32 s54, s54, 8192
s_cmp_eq_u32 s54, 81920
s_cselect_b32 s54, 0, s54
s_waitcnt vmcnt(22)
buffer_load_dwordx4 v17, s[20:23], s40 offen offset:1024 nt lds
s_add_u32 s42, s42, 1
s_add_u32 s53, s53, 1
s_cmp_eq_u32 s42, s50
s_cselect_b32 s53, 0, s53
ds_read2_b32 v[32:33], v31 offset0:64 offset1:128
s_waitcnt vmcnt(23)
buffer_load_dwordx4 v18, s[20:23], s40 offen offset:2048 nt lds
v_readlane_b32 s56, v24, s53
v_readlane_b32 s57, v25, s53
s_cmp_eq_u32 s53, s49
s_cselect_b64 s[72:73], -1, 0
s_waitcnt vmcnt(23)
buffer_load_dwordx4 v19, s[20:23], s40 offen offset:3072 nt lds
s_add_u32 m0, m0, 4096
s_sub_u32 s44, s42, 10
s_waitcnt vmcnt(23)
buffer_load_dwordx4 v20, s[20:23], s41 offen offset:0 nt lds
s_waitcnt lgkmcnt(0)
v_readfirstlane_b32 s94, v32
v_readfirstlane_b32 s95, v33
s_waitcnt vmcnt(22)
buffer_load_dwordx4 v21, s[20:23], s41 offen offset:1024 nt lds
s_min_i32 s48, s95, s94
s_cmp_gt_i32 s48, s44
s_cselect_b32 s48, s62, s42
s_waitcnt vmcnt(23)
buffer_load_dwordx4 v22, s[20:23], s41 offen offset:2048 nt lds
v_cndmask_b32 v16, v4, v8, s[72:73]
v_cndmask_b32 v17, v5, v9, s[72:73]
v_cndmask_b32 v18, v6, v10, s[72:73]
v_cndmask_b32 v19, v7, v11, s[72:73]
s_waitcnt vmcnt(23)
v_add_u32 v30, 1, v30
ds_write_b32 v31, v30
buffer_load_dwordx4 v23, s[20:23], s41 offen offset:3072 nt lds
s_cmp_ge_u32 s42, s50
s_cselect_b32 s20, s8, s6
s_cselect_b32 s21, s9, s7
s_mov_b32 s40, s56
s_mov_b32 s41, s57
s_mov_b32 m0, s54
s_cmp_lg_u32 s48, s42
s_waitcnt vmcnt(23)
s_cbranch_scc1 L_first95
s_branch L_top95
L_N96:
s_add_i32 s43, s42, -3
v_mov_b32 v30, s43
s_branch L_go96
L_top96:
L_chk96:
s_waitcnt lgkmcnt(0)
v_readfirstlane_b32 s94, v32
v_readfirstlane_b32 s95, v33
s_min_i32 s48, s95, s94
s_cmp_gt_i32 s48, s44
s_cbranch_scc1 L_ok96
ds_read2_b32 v[32:33], v31 offset0:64 offset1:128
s_branch L_chk96
L_ok96:
s_cmp_eq_u32 s42, s62
s_cbranch_scc1 L_evt
L_go96:
s_mov_b32 m0, s54
s_nop 0
L_first96:
buffer_load_dwordx4 v16, s[20:23], s40 offen offset:0 nt lds
v_cndmask_b32 v20, v4, v12, s[72:73]
v_cndmask_b32 v21, v5, v13, s[72:73]
v_cndmask_b32 v22, v6, v14, s[72:73]
v_cndmask_b32 v23, v7, v15, s[72:73]
s_add_u32 s54, s54, 8192
s_cmp_eq_u32 s54, 81920
s_cselect_b32 s54, 0, s54
s_waitcnt vmcnt(23)
buffer_load_dwordx4 v17, s[20:23], s40 offen offset:1024 nt lds
s_add_u32 s42, s42, 1
s_add_u32 s53, s53, 1
s_cmp_eq_u32 s42, s50
s_cselect_b32 s53, 0, s53
ds_read2_b32 v[32:33], v31 offset0:64 offset1:128
s_waitcnt vmcnt(23)
buffer_load_dwordx4 v18, s[20:23], s40 offen offset:2048 nt lds
v_readlane_b32 s56, v24, s53
v_readlane_b32 s57, v25, s53
s_cmp_eq_u32 s53, s49
s_cselect_b64 s[72:73], -1, 0
s_waitcnt vmcnt(23)
buffer_load_dwordx4 v19, s[20:23], s40 offen offset:3072 nt lds
s_add_u32 m0, m0, 4096
s_sub_u32 s44, s42, 10
s_waitcnt vmcnt(23)
buffer_load_dwordx4 v20, s[20:23], s41 offen offset:0 nt lds
s_waitcnt lgkmcnt(0)
v_readfirstlane_b32 s94, v32
v_readfirstlane_b32 s95, v33
s_waitcnt vmcnt(23)
buffer_load_dwordx4 v21, s[20:23], s41 offen offset:1024 nt lds
s_min_i32 s48, s95, s94
s_cmp_gt_i32 s48, s44
s_cselect_b32 s48, s62, s42
s_waitcnt vmcnt(23)
buffer_load_dwordx4 v22, s[20:23], s41 offen offset:2048 nt lds
v_cndmask_b32 v16, v4, v8, s[72:73]
v_cndmask_b32 v17, v5, v9, s[72:73]
v_cndmask_b32 v18, v6, v10, s[72:73]
v_cndmask_b32 v19, v7, v11, s[72:73]
s_waitcnt vmcnt(23)
v_add_u32 v30, 1, v30
ds_write_b32 v31, v30
buffer_load_dwordx4 v23, s[20:23], s41 offen offset:3072 nt lds
s_cmp_ge_u32 s42, s50
s_cselect_b32 s20, s8, s6
s_cselect_b32 s21, s9, s7
s_mov_b32 s40, s56
s_mov_b32 s41, s57
s_mov_b32 m0, s54
s_cmp_lg_u32 s48, s42
s_waitcnt vmcnt(23)
s_cbranch_scc1 L_first96
s_branch L_top96
L_N104:
s_add_i32 s43, s42, -4
v_mov_b32 v30, s43
s_branch L_go104
L_top104:
L_chk104:
s_waitcnt lgkmcnt(0)
v_readfirstlane_b32 s94, v32
v_readfirstlane_b32 s95, v33
s_min_i32 s48, s95, s94
s_cmp_gt_i32 s48, s44
s_cbranch_scc1 L_ok104
ds_read2_b32 v[32:33], v31 offset0:64 offset1:128
s_branch L_chk104
L_ok104:
s_cmp_eq_u32 s42, s62
s_cbranch_scc1 L_evt
L_go104:
s_mov_b32 m0, s54
s_nop 0
L_first104:
buffer_load_dwordx4 v16, s[20:23], s40 offen offset:0 nt lds
v_cndmask_b32 v20, v4, v12, s[72:73]
v_cndmask_b32 v21, v5, v13, s[72:73]
v_cndmask_b32 v22, v6, v14, s[72:73]
v_cndmask_b32 v23, v7, v15, s[72:73]
s_add_u32 s54, s54, 8192
s_cmp_eq_u32 s54, 81920
s_cselect_b32 s54, 0, s54
s_waitcnt vmcnt(25)
v_add_u32 v30, 1, v30
ds_write_b32 v31, v30
buffer_load_dwordx4 v17, s[20:23], s40 offen offset:1024 nt lds
s_add_u32 s42, s42, 1
s_add_u32 s53, s53, 1
s_cmp_eq_u32 s42, s50
s_cselect_b32 s53, 0, s53
ds_read2_b32 v[32:33], v31 offset0:64 offset1:128
s_waitcnt vmcnt(25)
buffer_load_dwordx4 v18, s[20:23], s40 offen offset:2048 nt lds
v_readlane_b32 s56, v24, s53
v_readlane_b32 s57, v25, s53
s_cmp_eq_u32 s53, s49
s_cselect_b64 s[72:73], -1, 0
s_waitcnt vmcnt(25)
buffer_load_dwordx4 v19, s[20:23], s40 offen offset:3072 nt lds
s_add_u32 m0, m0, 4096
s_sub_u32 s44, s42, 10
s_waitcnt vmcnt(25)
buffer_load_dwordx4 v20, s[20:23], s41 offen offset:0 nt lds
s_waitcnt lgkmcnt(0)
v_readfirstlane_b32 s94, v32
v_readfirstlane_b32 s95, v33
s_waitcnt vmcnt(25)
buffer_load_dwordx4 v21, s[20:23], s41 offen offset:1024 nt lds
s_min_i32 s48, s95, s94
s_cmp_gt_i32 s48, s44
s_cselect_b32 s48, s62, s42
s_waitcnt vmcnt(25)
buffer_load_dwordx4 v22, s[20:23], s41 offen offset:2048 nt lds
v_cndmask_b32 v16, v4, v8, s[72:73]
v_cndmask_b32 v17, v5, v9, s[72:73]
v_cndmask_b32 v18, v6, v10, s[72:73]
v_cndmask_b32 v19, v7, v11, s[72:73]
s_waitcnt vmcnt(25)
buffer_load_dwordx4 v23, s[20:23], s41 offen offset:3072 nt lds
s_cmp_ge_u32 s42, s50
s_cselect_b32 s20, s8, s6
s_cselect_b32 s21, s9, s7
s_mov_b32 s40, s56
s_mov_b32 s41, s57
s_mov_b32 m0, s54
s_cmp_lg_u32 s48, s42
s_waitcnt vmcnt(25)
s_cbranch_scc1 L_first104
s_branch L_top104
L_N112:
s_add_i32 s43, s42, -4
v_mov_b32 v30, s43
s_branch L_go112
L_top112:
L_chk112:
s_waitcnt lgkmcnt(0)
v_readfirstlane_b32 s94, v32
v_readfirstlane_b32 s95, v33
s_min_i32 s48, s95, s94
s_cmp_gt_i32 s48, s44
s_cbranch_scc1 L_ok112
ds_read2_b32 v[32:33], v31 offset0:64 offset1:128
s_branch L_chk112
L_ok112:
s_cmp_eq_u32 s42, s62
s_cbranch_scc1 L_evt
L_go112:
s_mov_b32 m0, s54
s_nop 0
L_first112:
buffer_load_dwordx4 v16, s[20:23], s40 offen offset:0 nt lds
v_cndmask_b32 v20, v4, v12, s[72:73]
v_cndmask_b32 v21, v5, v13, s[72:73]
v_cndmask_b32 v22, v6, v14, s[72:73]
v_cndmask_b32 v23, v7, v15, s[72:73]
s_add_u32 s54, s54, 8192
s_cmp_eq_u32 s54, 81920
s_cselect_b32 s54, 0, s54
s_waitcnt vmcnt(27)
buffer_load_dwordx4 v17, s[20:23], s40 offen offset:1024 nt lds
s_add_u32 s42, s42, 1
s_add_u32 s53, s53, 1
s_cmp_eq_u32 s42, s50
s_cselect_b32 s53, 0, s53
ds_read2_b32 v[32:33], v31 offset0:64 offset1:128
s_waitcnt vmcnt(27)
buffer_load_dwordx4 v18, s[20:23], s40 offen offset:2048 nt lds
v_readlane_b32 s56, v24, s53
v_readlane_b32 s57, v25, s53
s_cmp_eq_u32 s53, s49
s_cselect_b64 s[72:73], -1, 0
s_waitcnt vmcnt(27)
v_add_u32 v30, 1, v30
ds_write_b32 v31, v30
buffer_load_dwordx4 v19, s[20:23], s40 offen offset:3072 nt lds
s_add_u32 m0, m0, 4096
s_sub_u32 s44, s42, 10
s_waitcnt vmcnt(27)
buffer_load_dwordx4 v20, s[20:23], s41 offen offset:0 nt lds
s_waitcnt lgkmcnt(0)
v_readfirstlane_b32 s94, v32
v_readfirstlane_b32 s95, v33
s_waitcnt vmcnt(27)
buffer_load_dwordx4 v21, s[20:23], s41 offen offset:1024 nt lds
s_min_i32 s48, s95, s94
s_cmp_gt_i32 s48, s44
s_cselect_b32 s48, s62, s42
s_waitcnt vmcnt(27)
buffer_load_dwordx4 v22, s[20:23], s41 offen offset:2048 nt lds
v_cndmask_b32 v16, v4, v8, s[72:73]
v_cndmask_b32 v17, v5, v9, s[72:73]
v_cndmask_b32 v18, v6, v10, s[72:73]
v_cndmask_b32 v19, v7, v11, s[72:73]
s_waitcnt vmcnt(27)
buffer_load_dwordx4 v23, s[20:23], s41 offen offset:3072 nt lds
s_cmp_ge_u32 s42, s50
s_cselect_b32 s20, s8, s6
s_cselect_b32 s21, s9, s7
s_mov_b32 s40, s56
s_mov_b32 s41, s57
s_mov_b32 m0, s54
s_cmp_lg_u32 s48, s42
s_waitcnt vmcnt(27)
s_cbranch_scc1 L_first112
s_branch L_top112
L_N128:
s_add_i32 s43, s42, -4
v_mov_b32 v30, s43
s_branch L_go128
L_top128:
L_chk128:
s_waitcnt lgkmcnt(0)
v_readfirstlane_b32 s94, v32
v_readfirstlane_b32 s95, v33
s_min_i32 s48, s95, s94
s_cmp_gt_i32 s48, s44
s_cbranch_scc1 L_ok128
ds_read2_b32 v[32:33], v31 offset0:64 offset1:128
s_branch L_chk128
L_ok128:
s_cmp_eq_u32 s42, s62
s_cbranch_scc1 L_evt
L_go128:
s_mov_b32 m0, s54
s_nop 0
L_first128:
buffer_load_dwordx4 v16, s[20:23], s40 offen offset:0 nt lds
v_cndmask_b32 v20, v4, v12, s[72:73]
v_cndmask_b32 v21, v5, v13, s[72:73]
v_cndmask_b32 v22, v6, v14, s[72:73]
v_cndmask_b32 v23, v7, v15, s[72:73]
s_add_u32 s54, s54, 8192
s_cmp_eq_u32 s54, 81920
s_cselect_b32 s54, 0, s54
s_waitcnt vmcnt(31)
buffer_load_dwordx4 v17, s[20:23], s40 offen offset:1024 nt lds
s_add_u32 s42, s42, 1
s_add_u32 s53, s53, 1
s_cmp_eq_u32 s42, s50
s_cselect_b32 s53, 0, s53
ds_read2_b32 v[32:33], v31 offset0:64 offset1:128
s_waitcnt vmcnt(31)
buffer_load_dwordx4 v18, s[20:23], s40 offen offset:2048 nt lds
v_readlane_b32 s56, v24, s53
v_readlane_b32 s57, v25, s53
s_cmp_eq_u32 s53, s49
s_cselect_b64 s[72:73], -1, 0
s_waitcnt vmcnt(31)
buffer_load_dwordx4 v19, s[20:23], s40 offen offset:3072 nt lds
s_add_u32 m0, m0, 4096
s_sub_u32 s44, s42, 10
s_waitcnt vmcnt(31)
buffer_load_dwordx4 v20, s[20:23], s41 offen offset:0 nt lds
s_waitcnt lgkmcnt(0)
v_readfirstlane_b32 s94, v32
v_readfirstlane_b32 s95, v33
s_waitcnt vmcnt(31)
buffer_load_dwordx4 v21, s[20:23], s41 offen offset:1024 nt lds
s_min_i32 s48, s95, s94
s_cmp_gt_i32 s48, s44
s_cselect_b32 s48, s62, s42
s_waitcnt vmcnt(31)
buffer_load_dwordx4 v22, s[20:23], s41 offen offset:2048 nt lds
v_cndmask_b32 v16, v4, v8, s[72:73]
v_cndmask_b32 v17, v5, v9, s[72:73]
v_cndmask_b32 v18, v6, v10, s[72:73]
v_cndmask_b32 v19, v7, v11, s[72:73]
s_waitcnt vmcnt(31)
v_add_u32 v30, 1, v30
ds_write_b32 v31, v30
buffer_load_dwordx4 v23, s[20:23], s41 offen offset:3072 nt lds
s_cmp_ge_u32 s42, s50
s_cselect_b32 s20, s8, s6
s_cselect_b32 s21, s9, s7
s_mov_b32 s40, s56
s_mov_b32 s41, s57
s_mov_b32 m0, s54
s_cmp_lg_u32 s48, s42
s_waitcnt vmcnt(31)
s_cbranch_scc1 L_first128
s_branch L_top128
L_end:
s_endpgm
.section .rodata,"a"
.p2align 6
.amdhsa_kernel standalone__paged_block_table_kv_pagedattention__sampling_kernel
  .amdhsa_next_free_vgpr 196
  .amdhsa_next_free_sgpr 102
  .amdhsa_accum_offset 196
  .amdhsa_group_segment_fixed_size 0
  .amdhsa_kernarg_size 64
  .amdhsa_user_sgpr_count 2
  .amdhsa_user_sgpr_kernarg_segment_ptr 1
  .amdhsa_system_sgpr_workgroup_id_x 1
.end_amdhsa_kernel
```
